```python
import torch

def _softmax(x, axis=-1):
    return torch.softmax(x, dim=axis)
def _gelu(x):
    return torch.nn.functional.gelu(x, approximate="tanh")
def _silu(x):
    return torch.nn.functional.silu(x)
def _sigmoid(x):
    return torch.sigmoid(x)
def _layernorm(x, axis=-1, eps=1e-5):
    m = x.mean(dim=axis, keepdim=True)
    v = x.var(dim=axis, keepdim=True, unbiased=False)
    return (x - m) / torch.sqrt(v + eps)
def _scatter_add(tgt, idx, src, axis=0):
    return tgt.clone().index_add_(axis, idx, src)
def _segment_sum(src, seg, n):
    out = torch.zeros((n,) + src.shape[1:], dtype=src.dtype)
    return out.index_add_(0, seg, src)
def _pad(x, pw):
    flat = tuple(v for pair in reversed(pw) for v in pair)
    return torch.nn.functional.pad(x, flat)

kernel_name = 'parallel_sum__ssm_conv_s4d__dense_activation_relu__prompt'

def setup_inputs():

    _w = (lambda a: (lambda t: t.to(torch.bfloat16) if t.is_floating_point() else t)(torch.as_tensor(a)))
    def _A_setup():
        Bsz, L, D, N = 1, 2048, 640, 128
        return {
            "u": _w((lambda *s: torch.randn(*s, dtype=torch.bfloat16) * 0.05)(Bsz, L, D)),
            "log_A_real": _w((lambda *s: torch.randn(*s, dtype=torch.bfloat16) * 6.4)(D, N) * 0.5),
            "A_imag": _w((lambda *s: torch.randn(*s, dtype=torch.bfloat16) * 0.2)(D, N) * 3.14),
            "C_real": _w((lambda *s: torch.randn(*s, dtype=torch.bfloat16) * 0.8)(D, N) / N ** 0.5),
            "C_imag": _w((lambda *s: torch.randn(*s, dtype=torch.bfloat16) * 0.8)(D, N) / N ** 0.5),
            "log_dt": _w((lambda *s: torch.randn(*s, dtype=torch.bfloat16) * 0.2)(D) * 0.5 - 4.0),
            "D_skip": _w((lambda *s: torch.randn(*s, dtype=torch.bfloat16) * 0.2)(D)),
        }
    _A_in = _A_setup()

    def _B_setup():
        B, S, D, Dff = 1, 2048, 640, 1728
        return {
            "x": _w((lambda *s: torch.randn(*s, dtype=torch.bfloat16) * 0.05)(B, S, D)),
            "w1": _w((lambda *s: torch.randn(*s, dtype=torch.bfloat16) * 0.05)(D, Dff)),
            "w2": _w((lambda *s: torch.randn(*s, dtype=torch.bfloat16) * 0.05)(Dff, D)),
        }
    _B_in = _B_setup()

    return {
        "A_u": _A_in["u"],
        "A_log_A_real": _A_in["log_A_real"],
        "A_A_imag": _A_in["A_imag"],
        "A_C_real": _A_in["C_real"],
        "A_C_imag": _A_in["C_imag"],
        "A_log_dt": _A_in["log_dt"],
        "A_D_skip": _A_in["D_skip"],
        "B_x": _B_in["x"],
        "B_w1": _B_in["w1"],
        "B_w2": _B_in["w2"],
    }

def reference(A_u, A_log_A_real, A_A_imag, A_C_real, A_C_imag, A_log_dt, A_D_skip, B_x, B_w1, B_w2):
    def _A_ref(u, log_A_real, A_imag, C_real, C_imag, log_dt, D_skip):
        L = u.shape[1]
        dt = torch.exp(log_dt)
        A = -torch.exp(log_A_real) + 1j * A_imag
        C = (C_real + 1j * C_imag) * dt[:, None]
        pos = (lambda x, dt: x.to(dt))(torch.arange(L), log_dt.dtype)
        P = torch.exp((A * dt[:, None])[:, :, None] * pos[None, None, :])
        K = 2.0 * torch.einsum("dn,dnl->dl", C, P).real
        L2 = 2 * L
        u_t = (lambda x, *d: x.permute(*d))(u, 0, 2, 1)
        Kf = (lambda x, *a, **k: torch.fft.rfft(x.float(), *a, **k))(K, L2)
        Uf = (lambda x, *a, **k: torch.fft.rfft(x.float(), *a, **k))(u_t, L2)
        y = (lambda x, *a, **k: torch.fft.irfft(x, *a, **k).to(torch.bfloat16))(Uf * Kf[None, :, :], L2)[:, :, :L]
        y = (lambda x, *d: x.permute(*d))(y, 0, 2, 1)
        return y + u * D_skip[None, None, :]

    def _B_ref(x, w1, w2):
        h = torch.einsum("bsd,df->bsf", x, w1)
        zero = torch.zeros_like(h)
        h = torch.maximum(h, zero)
        return torch.einsum("bsf,fd->bsd", h, w2)

    x = A_u
    xn = _layernorm(x, axis=-1)
    return x + _A_ref(xn, A_log_A_real, A_A_imag, A_C_real, A_C_imag, A_log_dt, A_D_skip) + _B_ref(xn, B_w1, B_w2)
```

```asm
; @launch grid=(256,1,1) block=(512,1,1) lds=163840
.amdgcn_target "amdgcn-amd-amdhsa--gfx950"
.text
.globl parallel_sum__ssm_conv_s4d__dense_activation_relu__prompt_kernel
.p2align 8
.type parallel_sum__ssm_conv_s4d__dense_activation_relu__prompt_kernel,@function
parallel_sum__ssm_conv_s4d__dense_activation_relu__prompt_kernel:
    s_cmp_ge_u32 s2, 256
    s_cbranch_scc1 k_end
    s_load_dwordx16 s[4:19], s[0:1], 0
    s_load_dwordx8 s[20:27], s[0:1], 64
    s_load_dwordx2 s[28:29], s[0:1], 96
    v_lshrrev_b32 v1, 6, v0
    v_and_b32 v0, 63, v0
    v_readfirstlane_b32 s30, v1
    s_cmp_ge_u32 s2, 80
    s_cbranch_scc1 role_g
    s_and_b32 s54, s2, 7
    s_lshr_b32 s55, s2, 3
    s_mul_i32 s66, s54, 10
    s_add_u32 s66, s66, s55
    s_or_b32 s52, s2, s30
    s_memrealtime s[64:65]
    s_waitcnt lgkmcnt(0)
    s_cmp_lg_u32 s52, 0
    s_cbranch_scc1 no_pub
    s_or_b32 s64, s64, 1
    v_mov_b32 v1, s64
    v_mov_b32 v2, 0
    s_mov_b64 exec, 1
    global_store_dword v2, v1, s[26:27] sc1
    s_mov_b64 exec, -1
no_pub:
    s_mov_b32 s32, s4
    s_and_b32 s33, s5, 0xffff
    s_mov_b32 s34, 0x280000
    s_mov_b32 s35, 0x20000
    s_mov_b32 s40, s28
    s_and_b32 s41, s29, 0xffff
    s_mov_b32 s42, 0x2000000
    s_mov_b32 s43, 0x20000
    s_mov_b32 s36, s20
    s_and_b32 s37, s21, 0xffff
    s_mov_b32 s38, 0x21c000
    s_mov_b32 s39, 0x20000
    s_mov_b32 s72, s22
    s_and_b32 s73, s23, 0xffff
    s_mov_b32 s74, 0x21c000
    s_mov_b32 s75, 0x20000
    s_and_b32 s54, s2, 7
    s_lshr_b32 s55, s2, 3
    s_lshl_b32 s64, s54, 3
    s_add_u32 s64, s64, s55
    s_lshl_b32 s64, s64, 3
    s_add_u32 s64, s64, s30
    s_lshl_b32 s64, s64, 2
    s_cmp_ge_u32 s2, 64
    s_cselect_b32 s64, 4096, s64
    v_lshrrev_b32 v112, 4, v0
    v_add_u32 v112, s64, v112
    v_mul_u32_u24 v108, 1280, v112
    v_and_b32 v113, 15, v0
    v_lshl_add_u32 v108, v113, 4, v108
    buffer_load_dwordx4 v[48:51], v108, s[32:35], 0 offen offset:0
    buffer_load_dwordx4 v[52:55], v108, s[32:35], 0 offen offset:256
    buffer_load_dwordx4 v[56:59], v108, s[32:35], 0 offen offset:512
    buffer_load_dwordx4 v[60:63], v108, s[32:35], 0 offen offset:768
    buffer_load_dwordx4 v[64:67], v108, s[32:35], 0 offen offset:1024
    s_lshl_b32 s60, s66, 3
    s_add_u32 s60, s60, s30
    s_lshl_b32 s52, s60, 8
    v_lshlrev_b32 v8, 2, v0
    v_add_u32 v8, s52, v8
    global_load_dword v4, v8, s[6:7]
    global_load_dword v5, v8, s[8:9]
    global_load_dword v6, v8, s[10:11]
    global_load_dword v7, v8, s[12:13]
    s_lshr_b32 s52, s60, 1
    s_lshl_b32 s52, s52, 2
    s_load_dword s61, s[14:15], s52
    s_load_dword s62, s[16:17], s52
    s_lshr_b32 s65, s54, 1
    s_mul_i32 s65, s65, 7
    s_add_u32 s65, s65, s55
    s_sub_u32 s65, s65, 3
    s_cmp_lt_u32 s55, 3
    s_cselect_b32 s65, 99, s65
    s_cmp_lt_u32 s65, 27
    s_cselect_b32 s68, 1, 0
    s_sub_u32 s56, 53, s65
    s_bitcmp1_b32 s2, 0
    s_cselect_b32 s65, s56, s65
    s_cmp_eq_u32 s68, 0
    s_cselect_b32 s65, 0x10000, s65
    v_mov_b32 v122, 162304
    v_mov_b32 v123, 0
    ds_write_b32 v122, v123
    s_waitcnt vmcnt(4)
    v_mov_b32 v2, 0
    global_load_dword v1, v2, s[26:27] sc1
    s_mul_i32 s69, s30, 276480
    s_lshl_b32 s70, s65, 6
    s_add_u32 s69, s69, s70
    v_lshrrev_b32 v40, 2, v0
    v_mul_u32_u24 v40, 3456, v40
    v_and_b32 v41, 3, v0
    v_lshl_add_u32 v40, v41, 4, v40
    buffer_load_dwordx4 v[12:15], v40, s[36:39], s69 offen
    s_add_u32 s69, s69, 55296
    buffer_load_dwordx4 v[16:19], v40, s[36:39], s69 offen
    s_add_u32 s69, s69, 55296
    buffer_load_dwordx4 v[20:23], v40, s[36:39], s69 offen
    s_add_u32 s69, s69, 55296
    buffer_load_dwordx4 v[24:27], v40, s[36:39], s69 offen
    s_add_u32 s69, s69, 55296
    buffer_load_dwordx4 v[28:31], v40, s[36:39], s69 offen
    s_cmp_ge_u32 s2, 64
    s_cbranch_scc1 no_p1
    v_lshlrev_b32 v108, 3, v112
    v_lshlrev_b32 v68, 16, v48
    v_and_b32 v69, 0xffff0000, v48
    v_lshlrev_b32 v70, 16, v49
    v_and_b32 v71, 0xffff0000, v49
    v_lshlrev_b32 v72, 16, v50
    v_and_b32 v73, 0xffff0000, v50
    v_lshlrev_b32 v74, 16, v51
    v_and_b32 v75, 0xffff0000, v51
    v_lshlrev_b32 v76, 16, v52
    v_and_b32 v77, 0xffff0000, v52
    v_lshlrev_b32 v78, 16, v53
    v_and_b32 v79, 0xffff0000, v53
    v_lshlrev_b32 v80, 16, v54
    v_and_b32 v81, 0xffff0000, v54
    v_lshlrev_b32 v82, 16, v55
    v_and_b32 v83, 0xffff0000, v55
    v_lshlrev_b32 v84, 16, v56
    v_and_b32 v85, 0xffff0000, v56
    v_lshlrev_b32 v86, 16, v57
    v_and_b32 v87, 0xffff0000, v57
    v_lshlrev_b32 v88, 16, v58
    v_and_b32 v89, 0xffff0000, v58
    v_lshlrev_b32 v90, 16, v59
    v_and_b32 v91, 0xffff0000, v59
    v_lshlrev_b32 v92, 16, v60
    v_and_b32 v93, 0xffff0000, v60
    v_lshlrev_b32 v94, 16, v61
    v_and_b32 v95, 0xffff0000, v61
    v_lshlrev_b32 v96, 16, v62
    v_and_b32 v97, 0xffff0000, v62
    v_lshlrev_b32 v98, 16, v63
    v_and_b32 v99, 0xffff0000, v63
    v_lshlrev_b32 v100, 16, v64
    v_and_b32 v101, 0xffff0000, v64
    v_lshlrev_b32 v102, 16, v65
    v_and_b32 v103, 0xffff0000, v65
    v_lshlrev_b32 v104, 16, v66
    v_and_b32 v105, 0xffff0000, v66
    v_lshlrev_b32 v106, 16, v67
    v_and_b32 v107, 0xffff0000, v67
    v_pk_add_f32 v[110:111], v[68:69], v[70:71]
    v_pk_add_f32 v[116:117], v[72:73], v[74:75]
    v_pk_add_f32 v[110:111], v[110:111], v[76:77]
    v_pk_add_f32 v[116:117], v[116:117], v[78:79]
    v_pk_add_f32 v[110:111], v[110:111], v[80:81]
    v_pk_add_f32 v[116:117], v[116:117], v[82:83]
    v_pk_add_f32 v[110:111], v[110:111], v[84:85]
    v_pk_add_f32 v[116:117], v[116:117], v[86:87]
    v_pk_add_f32 v[110:111], v[110:111], v[88:89]
    v_pk_add_f32 v[116:117], v[116:117], v[90:91]
    v_pk_add_f32 v[110:111], v[110:111], v[92:93]
    v_pk_add_f32 v[116:117], v[116:117], v[94:95]
    v_pk_add_f32 v[110:111], v[110:111], v[96:97]
    v_pk_add_f32 v[116:117], v[116:117], v[98:99]
    v_pk_add_f32 v[110:111], v[110:111], v[100:101]
    v_pk_add_f32 v[116:117], v[116:117], v[102:103]
    v_pk_add_f32 v[110:111], v[110:111], v[104:105]
    v_pk_add_f32 v[116:117], v[116:117], v[106:107]
    v_pk_add_f32 v[110:111], v[110:111], v[116:117]
    v_add_f32 v110, v110, v111
    s_nop 1
    v_add_f32_dpp v110, v110, v110 row_ror:8 row_mask:0xf bank_mask:0xf
    s_nop 1
    v_add_f32_dpp v110, v110, v110 row_ror:4 row_mask:0xf bank_mask:0xf
    s_nop 1
    v_add_f32_dpp v110, v110, v110 row_ror:2 row_mask:0xf bank_mask:0xf
    s_nop 1
    v_add_f32_dpp v110, v110, v110 row_ror:1 row_mask:0xf bank_mask:0xf
    v_mul_f32 v114, 0x3acccccd, v110
    v_pk_add_f32 v[48:49], v[68:69], v[114:115] op_sel_hi:[1,0] neg_lo:[0,1] neg_hi:[0,1]
    v_pk_mul_f32 v[110:111], v[48:49], v[48:49]
    v_pk_add_f32 v[50:51], v[70:71], v[114:115] op_sel_hi:[1,0] neg_lo:[0,1] neg_hi:[0,1]
    v_pk_mul_f32 v[116:117], v[50:51], v[50:51]
    v_pk_add_f32 v[52:53], v[72:73], v[114:115] op_sel_hi:[1,0] neg_lo:[0,1] neg_hi:[0,1]
    v_pk_fma_f32 v[110:111], v[52:53], v[52:53], v[110:111]
    v_pk_add_f32 v[54:55], v[74:75], v[114:115] op_sel_hi:[1,0] neg_lo:[0,1] neg_hi:[0,1]
    v_pk_fma_f32 v[116:117], v[54:55], v[54:55], v[116:117]
    v_pk_add_f32 v[48:49], v[76:77], v[114:115] op_sel_hi:[1,0] neg_lo:[0,1] neg_hi:[0,1]
    v_pk_fma_f32 v[110:111], v[48:49], v[48:49], v[110:111]
    v_pk_add_f32 v[50:51], v[78:79], v[114:115] op_sel_hi:[1,0] neg_lo:[0,1] neg_hi:[0,1]
    v_pk_fma_f32 v[116:117], v[50:51], v[50:51], v[116:117]
    v_pk_add_f32 v[52:53], v[80:81], v[114:115] op_sel_hi:[1,0] neg_lo:[0,1] neg_hi:[0,1]
    v_pk_fma_f32 v[110:111], v[52:53], v[52:53], v[110:111]
    v_pk_add_f32 v[54:55], v[82:83], v[114:115] op_sel_hi:[1,0] neg_lo:[0,1] neg_hi:[0,1]
    v_pk_fma_f32 v[116:117], v[54:55], v[54:55], v[116:117]
    v_pk_add_f32 v[48:49], v[84:85], v[114:115] op_sel_hi:[1,0] neg_lo:[0,1] neg_hi:[0,1]
    v_pk_fma_f32 v[110:111], v[48:49], v[48:49], v[110:111]
    v_pk_add_f32 v[50:51], v[86:87], v[114:115] op_sel_hi:[1,0] neg_lo:[0,1] neg_hi:[0,1]
    v_pk_fma_f32 v[116:117], v[50:51], v[50:51], v[116:117]
    v_pk_add_f32 v[52:53], v[88:89], v[114:115] op_sel_hi:[1,0] neg_lo:[0,1] neg_hi:[0,1]
    v_pk_fma_f32 v[110:111], v[52:53], v[52:53], v[110:111]
    v_pk_add_f32 v[54:55], v[90:91], v[114:115] op_sel_hi:[1,0] neg_lo:[0,1] neg_hi:[0,1]
    v_pk_fma_f32 v[116:117], v[54:55], v[54:55], v[116:117]
    v_pk_add_f32 v[48:49], v[92:93], v[114:115] op_sel_hi:[1,0] neg_lo:[0,1] neg_hi:[0,1]
    v_pk_fma_f32 v[110:111], v[48:49], v[48:49], v[110:111]
    v_pk_add_f32 v[50:51], v[94:95], v[114:115] op_sel_hi:[1,0] neg_lo:[0,1] neg_hi:[0,1]
    v_pk_fma_f32 v[116:117], v[50:51], v[50:51], v[116:117]
    v_pk_add_f32 v[52:53], v[96:97], v[114:115] op_sel_hi:[1,0] neg_lo:[0,1] neg_hi:[0,1]
    v_pk_fma_f32 v[110:111], v[52:53], v[52:53], v[110:111]
    v_pk_add_f32 v[54:55], v[98:99], v[114:115] op_sel_hi:[1,0] neg_lo:[0,1] neg_hi:[0,1]
    v_pk_fma_f32 v[116:117], v[54:55], v[54:55], v[116:117]
    v_pk_add_f32 v[48:49], v[100:101], v[114:115] op_sel_hi:[1,0] neg_lo:[0,1] neg_hi:[0,1]
    v_pk_fma_f32 v[110:111], v[48:49], v[48:49], v[110:111]
    v_pk_add_f32 v[50:51], v[102:103], v[114:115] op_sel_hi:[1,0] neg_lo:[0,1] neg_hi:[0,1]
    v_pk_fma_f32 v[116:117], v[50:51], v[50:51], v[116:117]
    v_pk_add_f32 v[52:53], v[104:105], v[114:115] op_sel_hi:[1,0] neg_lo:[0,1] neg_hi:[0,1]
    v_pk_fma_f32 v[110:111], v[52:53], v[52:53], v[110:111]
    v_pk_add_f32 v[54:55], v[106:107], v[114:115] op_sel_hi:[1,0] neg_lo:[0,1] neg_hi:[0,1]
    v_pk_fma_f32 v[116:117], v[54:55], v[54:55], v[116:117]
    v_pk_add_f32 v[116:117], v[110:111], v[116:117]
    v_add_f32 v116, v116, v117
    s_nop 1
    v_add_f32_dpp v116, v116, v116 row_ror:8 row_mask:0xf bank_mask:0xf
    s_nop 1
    v_add_f32_dpp v116, v116, v116 row_ror:4 row_mask:0xf bank_mask:0xf
    s_nop 1
    v_add_f32_dpp v116, v116, v116 row_ror:2 row_mask:0xf bank_mask:0xf
    s_nop 1
    v_add_f32_dpp v116, v116, v116 row_ror:1 row_mask:0xf bank_mask:0xf
    v_mul_f32 v116, 0x3acccccd, v116
    v_cvt_pk_bf16_f32 v116, v116, v116
    v_lshlrev_b32 v116, 16, v116
    v_add_f32 v116, 0x3727c5ac, v116
    v_cvt_pk_bf16_f32 v116, v116, v116
    v_lshlrev_b32 v116, 16, v116
    v_sqrt_f32 v116, v116
    s_nop 0
    v_cvt_pk_bf16_f32 v118, v114, v116
    v_and_b32 v115, 0xffff0000, v118
    v_rcp_f32 v115, v115
    v_lshlrev_b32 v114, 16, v118
    v_and_b32 v120, 3, v0
    v_lshlrev_b32 v120, 1, v120
    v_xor_b32 v120, s30, v120
    v_lshlrev_b32 v120, 3, v120
    v_lshl_add_u32 v120, v113, 9, v120
    v_lshrrev_b32 v112, 4, v0
    v_lshl_add_u32 v120, v112, 7, v120
    s_mov_b32 s52, 0x05040100
    s_mov_b32 s53, 0x07060302
    v_pk_add_f32 v[68:69], v[68:69], v[114:115] op_sel_hi:[1,0] neg_lo:[0,1] neg_hi:[0,1]
    v_pk_add_f32 v[70:71], v[70:71], v[114:115] op_sel_hi:[1,0] neg_lo:[0,1] neg_hi:[0,1]
    v_pk_add_f32 v[72:73], v[72:73], v[114:115] op_sel_hi:[1,0] neg_lo:[0,1] neg_hi:[0,1]
    v_pk_add_f32 v[74:75], v[74:75], v[114:115] op_sel_hi:[1,0] neg_lo:[0,1] neg_hi:[0,1]
    v_pk_add_f32 v[76:77], v[76:77], v[114:115] op_sel_hi:[1,0] neg_lo:[0,1] neg_hi:[0,1]
    v_pk_add_f32 v[78:79], v[78:79], v[114:115] op_sel_hi:[1,0] neg_lo:[0,1] neg_hi:[0,1]
    v_pk_add_f32 v[80:81], v[80:81], v[114:115] op_sel_hi:[1,0] neg_lo:[0,1] neg_hi:[0,1]
    v_pk_add_f32 v[82:83], v[82:83], v[114:115] op_sel_hi:[1,0] neg_lo:[0,1] neg_hi:[0,1]
    v_pk_add_f32 v[84:85], v[84:85], v[114:115] op_sel_hi:[1,0] neg_lo:[0,1] neg_hi:[0,1]
    v_pk_add_f32 v[86:87], v[86:87], v[114:115] op_sel_hi:[1,0] neg_lo:[0,1] neg_hi:[0,1]
    v_pk_add_f32 v[88:89], v[88:89], v[114:115] op_sel_hi:[1,0] neg_lo:[0,1] neg_hi:[0,1]
    v_pk_add_f32 v[90:91], v[90:91], v[114:115] op_sel_hi:[1,0] neg_lo:[0,1] neg_hi:[0,1]
    v_pk_add_f32 v[92:93], v[92:93], v[114:115] op_sel_hi:[1,0] neg_lo:[0,1] neg_hi:[0,1]
    v_pk_add_f32 v[94:95], v[94:95], v[114:115] op_sel_hi:[1,0] neg_lo:[0,1] neg_hi:[0,1]
    v_pk_add_f32 v[96:97], v[96:97], v[114:115] op_sel_hi:[1,0] neg_lo:[0,1] neg_hi:[0,1]
    v_pk_add_f32 v[98:99], v[98:99], v[114:115] op_sel_hi:[1,0] neg_lo:[0,1] neg_hi:[0,1]
    v_pk_add_f32 v[100:101], v[100:101], v[114:115] op_sel_hi:[1,0] neg_lo:[0,1] neg_hi:[0,1]
    v_pk_add_f32 v[102:103], v[102:103], v[114:115] op_sel_hi:[1,0] neg_lo:[0,1] neg_hi:[0,1]
    v_pk_add_f32 v[104:105], v[104:105], v[114:115] op_sel_hi:[1,0] neg_lo:[0,1] neg_hi:[0,1]
    v_pk_add_f32 v[106:107], v[106:107], v[114:115] op_sel_hi:[1,0] neg_lo:[0,1] neg_hi:[0,1]
    v_pk_mul_f32 v[68:69], v[68:69], v[114:115] op_sel:[0,1] op_sel_hi:[1,1]
    v_pk_mul_f32 v[70:71], v[70:71], v[114:115] op_sel:[0,1] op_sel_hi:[1,1]
    v_pk_mul_f32 v[72:73], v[72:73], v[114:115] op_sel:[0,1] op_sel_hi:[1,1]
    v_pk_mul_f32 v[74:75], v[74:75], v[114:115] op_sel:[0,1] op_sel_hi:[1,1]
    v_pk_mul_f32 v[76:77], v[76:77], v[114:115] op_sel:[0,1] op_sel_hi:[1,1]
    v_pk_mul_f32 v[78:79], v[78:79], v[114:115] op_sel:[0,1] op_sel_hi:[1,1]
    v_pk_mul_f32 v[80:81], v[80:81], v[114:115] op_sel:[0,1] op_sel_hi:[1,1]
    v_pk_mul_f32 v[82:83], v[82:83], v[114:115] op_sel:[0,1] op_sel_hi:[1,1]
    v_pk_mul_f32 v[84:85], v[84:85], v[114:115] op_sel:[0,1] op_sel_hi:[1,1]
    v_pk_mul_f32 v[86:87], v[86:87], v[114:115] op_sel:[0,1] op_sel_hi:[1,1]
    v_pk_mul_f32 v[88:89], v[88:89], v[114:115] op_sel:[0,1] op_sel_hi:[1,1]
    v_pk_mul_f32 v[90:91], v[90:91], v[114:115] op_sel:[0,1] op_sel_hi:[1,1]
    v_pk_mul_f32 v[92:93], v[92:93], v[114:115] op_sel:[0,1] op_sel_hi:[1,1]
    v_pk_mul_f32 v[94:95], v[94:95], v[114:115] op_sel:[0,1] op_sel_hi:[1,1]
    v_pk_mul_f32 v[96:97], v[96:97], v[114:115] op_sel:[0,1] op_sel_hi:[1,1]
    v_pk_mul_f32 v[98:99], v[98:99], v[114:115] op_sel:[0,1] op_sel_hi:[1,1]
    v_pk_mul_f32 v[100:101], v[100:101], v[114:115] op_sel:[0,1] op_sel_hi:[1,1]
    v_pk_mul_f32 v[102:103], v[102:103], v[114:115] op_sel:[0,1] op_sel_hi:[1,1]
    v_pk_mul_f32 v[104:105], v[104:105], v[114:115] op_sel:[0,1] op_sel_hi:[1,1]
    v_pk_mul_f32 v[106:107], v[106:107], v[114:115] op_sel:[0,1] op_sel_hi:[1,1]
    v_cvt_pk_bf16_f32 v48, v68, v69
    v_cvt_pk_bf16_f32 v49, v70, v71
    v_cvt_pk_bf16_f32 v50, v72, v73
    v_cvt_pk_bf16_f32 v51, v74, v75
    v_cvt_pk_bf16_f32 v52, v76, v77
    v_cvt_pk_bf16_f32 v53, v78, v79
    v_cvt_pk_bf16_f32 v54, v80, v81
    v_cvt_pk_bf16_f32 v55, v82, v83
    v_cvt_pk_bf16_f32 v56, v84, v85
    v_cvt_pk_bf16_f32 v57, v86, v87
    v_cvt_pk_bf16_f32 v58, v88, v89
    v_cvt_pk_bf16_f32 v59, v90, v91
    v_cvt_pk_bf16_f32 v60, v92, v93
    v_cvt_pk_bf16_f32 v61, v94, v95
    v_cvt_pk_bf16_f32 v62, v96, v97
    v_cvt_pk_bf16_f32 v63, v98, v99
    v_cvt_pk_bf16_f32 v64, v100, v101
    v_cvt_pk_bf16_f32 v65, v102, v103
    v_cvt_pk_bf16_f32 v66, v104, v105
    v_cvt_pk_bf16_f32 v67, v106, v107
    s_nop 1
    v_permlane32_swap_b32 v48, v50
    v_permlane32_swap_b32 v49, v51
    v_permlane32_swap_b32 v52, v54
    v_permlane32_swap_b32 v53, v55
    v_permlane32_swap_b32 v56, v58
    v_permlane32_swap_b32 v57, v59
    v_permlane32_swap_b32 v60, v62
    v_permlane32_swap_b32 v61, v63
    v_permlane32_swap_b32 v64, v66
    v_permlane32_swap_b32 v65, v67
    s_nop 1
    v_permlane16_swap_b32 v48, v49
    v_permlane16_swap_b32 v50, v51
    v_permlane16_swap_b32 v52, v53
    v_permlane16_swap_b32 v54, v55
    v_permlane16_swap_b32 v56, v57
    v_permlane16_swap_b32 v58, v59
    v_permlane16_swap_b32 v60, v61
    v_permlane16_swap_b32 v62, v63
    v_permlane16_swap_b32 v64, v65
    v_permlane16_swap_b32 v66, v67
    s_nop 1
    v_perm_b32 v68, v49, v48, s52
    v_perm_b32 v69, v51, v50, s52
    ds_write_b64 v120, v[68:69] offset:0
    v_perm_b32 v70, v49, v48, s53
    v_perm_b32 v71, v51, v50, s53
    ds_write_b64 v120, v[70:71] offset:64
    v_perm_b32 v72, v53, v52, s52
    v_perm_b32 v73, v55, v54, s52
    ds_write_b64 v120, v[72:73] offset:8192
    v_perm_b32 v74, v53, v52, s53
    v_perm_b32 v75, v55, v54, s53
    ds_write_b64 v120, v[74:75] offset:8256
    v_perm_b32 v76, v57, v56, s52
    v_perm_b32 v77, v59, v58, s52
    ds_write_b64 v120, v[76:77] offset:16384
    v_perm_b32 v78, v57, v56, s53
    v_perm_b32 v79, v59, v58, s53
    ds_write_b64 v120, v[78:79] offset:16448
    v_perm_b32 v80, v61, v60, s52
    v_perm_b32 v81, v63, v62, s52
    ds_write_b64 v120, v[80:81] offset:24576
    v_perm_b32 v82, v61, v60, s53
    v_perm_b32 v83, v63, v62, s53
    ds_write_b64 v120, v[82:83] offset:24640
    v_perm_b32 v84, v65, v64, s52
    v_perm_b32 v85, v67, v66, s52
    ds_write_b64 v120, v[84:85] offset:32768
    v_perm_b32 v86, v65, v64, s53
    v_perm_b32 v87, v67, v66, s53
    ds_write_b64 v120, v[86:87] offset:32832
    s_waitcnt vmcnt(5)
nz_lp_2:
    v_readfirstlane_b32 s67, v1
    s_cmp_lg_u32 s67, 0
    s_cbranch_scc1 nz_ok_1
    v_mov_b32 v2, 0
    global_load_dword v1, v2, s[26:27] sc1
    s_waitcnt vmcnt(0)
    s_branch nz_lp_2
nz_ok_1:
    v_mov_b32 v119, s67
    v_cmp_eq_u32 vcc, 0, v113
    s_mov_b32 s52, 0x700000
    s_and_saveexec_b64 s[54:55], vcc
    buffer_store_dwordx2 v[118:119], v108, s[40:43], s52 offen sc1
    s_mov_b64 exec, s[54:55]
    s_waitcnt lgkmcnt(0)
    s_barrier
    v_lshrrev_b32 v112, 5, v0
    s_lshl_b32 s52, s30, 1
    v_add_u32 v112, s52, v112
    v_xor_b32 v112, v112, v0
    v_and_b32 v112, 3, v112
    v_lshlrev_b32 v112, 4, v112
    v_lshrrev_b32 v113, 2, v0
    v_lshl_add_u32 v112, v113, 6, v112
    s_mul_i32 s52, s30, 5120
    v_add_u32 v112, s52, v112
    v_xor_b32 v120, 32, v112
    ds_read_b128 v[48:51], v112 offset:0
    ds_read_b128 v[52:55], v120 offset:1024
    ds_read_b128 v[56:59], v112 offset:2048
    ds_read_b128 v[60:63], v120 offset:3072
    ds_read_b128 v[64:67], v112 offset:4096
    v_lshlrev_b32 v108, 4, v0
    s_lshr_b32 s52, s64, 5
    s_mul_i32 s52, s52, 41344
    s_mul_i32 s53, s30, 5120
    s_add_u32 s52, s52, s53
    s_add_u32 s52, s52, 0xb00000
    s_waitcnt lgkmcnt(0)
    s_barrier
    buffer_store_dwordx4 v[48:51], v108, s[40:43], s52 offen offset:0 sc1
    buffer_store_dwordx4 v[52:55], v108, s[40:43], s52 offen offset:1024 sc1
    buffer_store_dwordx4 v[56:59], v108, s[40:43], s52 offen offset:2048 sc1
    buffer_store_dwordx4 v[60:63], v108, s[40:43], s52 offen offset:3072 sc1
    s_add_u32 s52, s52, 4096
    buffer_store_dwordx4 v[64:67], v108, s[40:43], s52 offen offset:0 sc1
    s_branch p1_done
no_p1:
    s_waitcnt vmcnt(5)
nz_lp_4:
    v_readfirstlane_b32 s67, v1
    s_cmp_lg_u32 s67, 0
    s_cbranch_scc1 nz_ok_3
    v_mov_b32 v2, 0
    global_load_dword v1, v2, s[26:27] sc1
    s_waitcnt vmcnt(0)
    s_branch nz_lp_4
nz_ok_3:
    s_waitcnt lgkmcnt(0)
    s_barrier
p1_done:
    s_mul_i32 s69, s30, 4576
    s_add_u32 s69, s69, 126976
    v_lshlrev_b32 v2, 3, v0
    v_add_u32 v2, s69, v2
    v_mov_b32 v46, 0
    v_mov_b32 v47, 0
    s_mov_b32 exec_hi, 0x0fffffff
    ds_write_b64 v2, v[46:47]
    s_mov_b32 exec_hi, -1
    s_setprio 1
    s_cmp_lt_u32 s30, 4
    s_cbranch_scc1 no_pry
    s_setprio 2
no_pry:
    s_mov_b32 s52, 0x3fb8aa3b
    s_mov_b32 s53, 0x32a57060
    s_mov_b32 s54, 0x3f317218
    s_mul_i32 s55, s30, 15872
    v_lshlrev_b32 v112, 2, v0
    v_add_u32 v112, s55, v112
    v_and_b32 v108, 31, v0
    v_mul_u32_u24 v108, 272, v108
    v_lshrrev_b32 v109, 5, v0
    v_lshl_add_u32 v108, v109, 4, v108
    v_add_u32 v113, s55, v108
    s_waitcnt lgkmcnt(0)
    s_and_b32 s56, s60, 1
    s_lshl_b32 s56, s56, 4
    s_lshr_b32 s61, s61, s56
    s_lshl_b32 s61, s61, 16
    s_lshr_b32 s62, s62, s56
    s_lshl_b32 s62, s62, 16
    v_mov_b32 v110, s61
    v_mul_f32 v108, s52, v110
    v_fma_f32 v109, v110, s52, -v108
    v_fmac_f32 v109, s53, v110
    v_exp_f32 v108, v108
    v_mul_f32 v109, s54, v109
    v_fma_f32 v108, v108, v109, v108
    v_cvt_pk_bf16_f32 v108, v108, v108
    v_lshlrev_b32 v80, 16, v108
    v_lshlrev_b32 v110, 16, v4
    v_mul_f32 v108, s52, v110
    v_fma_f32 v109, v110, s52, -v108
    v_fmac_f32 v109, s53, v110
    v_exp_f32 v108, v108
    v_mul_f32 v109, s54, v109
    v_fma_f32 v108, v108, v109, v108
    v_cvt_pk_bf16_f32 v108, v108, v108
    v_lshlrev_b32 v110, 16, v108
    v_mul_f32 v110, v110, v80
    v_mul_f32 v110, s52, v110
    v_lshlrev_b32 v111, 16, v5
    v_mul_f32 v111, v111, v80
    v_mul_f32 v111, 0.15915494, v111
    v_mul_f32 v108, 0xbf800000, v110
    v_mul_f32 v109, 0x3f800000, v111
    v_exp_f32 v108, v108
    v_fract_f32 v109, v109
    v_cos_f32 v82, v109
    v_sin_f32 v83, v109
    s_nop 0
    v_mul_f32 v82, v82, v108
    v_mul_f32 v83, v83, v108
    v_mul_f32 v108, 0xc1000000, v110
    v_mul_f32 v109, 0x41000000, v111
    v_exp_f32 v108, v108
    v_fract_f32 v109, v109
    v_cos_f32 v84, v109
    v_sin_f32 v85, v109
    s_nop 0
    v_mul_f32 v84, v84, v108
    v_mul_f32 v85, v85, v108
    v_mul_f32 v108, 0xc3800000, v110
    v_mul_f32 v109, 0x43800000, v111
    v_exp_f32 v108, v108
    v_fract_f32 v109, v109
    v_cos_f32 v86, v109
    v_sin_f32 v87, v109
    s_nop 0
    v_mul_f32 v86, v86, v108
    v_mul_f32 v87, v87, v108
    v_lshlrev_b32 v92, 16, v6
    v_lshlrev_b32 v93, 16, v7
    v_add_f32 v108, v80, v80
    v_mul_f32 v92, v92, v108
    v_mul_f32 v93, v93, v108
    v_mov_b32 v117, 0x3f80
    ds_write_b32 v112, v117 offset:0
    v_cvt_pk_bf16_f32 v114, v84, v85
    ds_write_b32 v112, v114 offset:272
    v_pk_mul_f32 v[90:91], v[84:85], v[84:85] op_sel_hi:[1,0]
    v_pk_fma_f32 v[88:89], v[84:85], v[84:85], v[90:91] op_sel:[1,1,0] op_sel_hi:[0,1,1] neg_lo:[1,0,0]
    v_cvt_pk_bf16_f32 v115, v88, v89
    ds_write_b32 v112, v115 offset:544
    v_pk_mul_f32 v[90:91], v[88:89], v[84:85] op_sel_hi:[1,0]
    v_pk_fma_f32 v[88:89], v[88:89], v[84:85], v[90:91] op_sel:[1,1,0] op_sel_hi:[0,1,1] neg_lo:[1,0,0]
    v_cvt_pk_bf16_f32 v116, v88, v89
    ds_write_b32 v112, v116 offset:816
    v_pk_mul_f32 v[90:91], v[88:89], v[84:85] op_sel_hi:[1,0]
    v_pk_fma_f32 v[88:89], v[88:89], v[84:85], v[90:91] op_sel:[1,1,0] op_sel_hi:[0,1,1] neg_lo:[1,0,0]
    v_cvt_pk_bf16_f32 v117, v88, v89
    ds_write_b32 v112, v117 offset:1088
    v_pk_mul_f32 v[90:91], v[88:89], v[84:85] op_sel_hi:[1,0]
    v_pk_fma_f32 v[88:89], v[88:89], v[84:85], v[90:91] op_sel:[1,1,0] op_sel_hi:[0,1,1] neg_lo:[1,0,0]
    v_cvt_pk_bf16_f32 v114, v88, v89
    ds_write_b32 v112, v114 offset:1360
    v_pk_mul_f32 v[90:91], v[88:89], v[84:85] op_sel_hi:[1,0]
    v_pk_fma_f32 v[88:89], v[88:89], v[84:85], v[90:91] op_sel:[1,1,0] op_sel_hi:[0,1,1] neg_lo:[1,0,0]
    v_cvt_pk_bf16_f32 v115, v88, v89
    ds_write_b32 v112, v115 offset:1632
    v_pk_mul_f32 v[90:91], v[88:89], v[84:85] op_sel_hi:[1,0]
    v_pk_fma_f32 v[88:89], v[88:89], v[84:85], v[90:91] op_sel:[1,1,0] op_sel_hi:[0,1,1] neg_lo:[1,0,0]
    v_cvt_pk_bf16_f32 v116, v88, v89
    ds_write_b32 v112, v116 offset:1904
    v_pk_mul_f32 v[90:91], v[88:89], v[84:85] op_sel_hi:[1,0]
    v_pk_fma_f32 v[88:89], v[88:89], v[84:85], v[90:91] op_sel:[1,1,0] op_sel_hi:[0,1,1] neg_lo:[1,0,0]
    v_cvt_pk_bf16_f32 v117, v88, v89
    ds_write_b32 v112, v117 offset:2176
    v_pk_mul_f32 v[90:91], v[88:89], v[84:85] op_sel_hi:[1,0]
    v_pk_fma_f32 v[88:89], v[88:89], v[84:85], v[90:91] op_sel:[1,1,0] op_sel_hi:[0,1,1] neg_lo:[1,0,0]
    v_cvt_pk_bf16_f32 v114, v88, v89
    ds_write_b32 v112, v114 offset:2448
    v_pk_mul_f32 v[90:91], v[88:89], v[84:85] op_sel_hi:[1,0]
    v_pk_fma_f32 v[88:89], v[88:89], v[84:85], v[90:91] op_sel:[1,1,0] op_sel_hi:[0,1,1] neg_lo:[1,0,0]
    v_cvt_pk_bf16_f32 v115, v88, v89
    ds_write_b32 v112, v115 offset:2720
    v_pk_mul_f32 v[90:91], v[88:89], v[84:85] op_sel_hi:[1,0]
    v_pk_fma_f32 v[88:89], v[88:89], v[84:85], v[90:91] op_sel:[1,1,0] op_sel_hi:[0,1,1] neg_lo:[1,0,0]
    v_cvt_pk_bf16_f32 v116, v88, v89
    ds_write_b32 v112, v116 offset:2992
    v_pk_mul_f32 v[90:91], v[88:89], v[84:85] op_sel_hi:[1,0]
    v_pk_fma_f32 v[88:89], v[88:89], v[84:85], v[90:91] op_sel:[1,1,0] op_sel_hi:[0,1,1] neg_lo:[1,0,0]
    v_cvt_pk_bf16_f32 v117, v88, v89
    ds_write_b32 v112, v117 offset:3264
    v_pk_mul_f32 v[90:91], v[88:89], v[84:85] op_sel_hi:[1,0]
    v_pk_fma_f32 v[88:89], v[88:89], v[84:85], v[90:91] op_sel:[1,1,0] op_sel_hi:[0,1,1] neg_lo:[1,0,0]
    v_cvt_pk_bf16_f32 v114, v88, v89
    ds_write_b32 v112, v114 offset:3536
    v_pk_mul_f32 v[90:91], v[88:89], v[84:85] op_sel_hi:[1,0]
    v_pk_fma_f32 v[88:89], v[88:89], v[84:85], v[90:91] op_sel:[1,1,0] op_sel_hi:[0,1,1] neg_lo:[1,0,0]
    v_cvt_pk_bf16_f32 v115, v88, v89
    ds_write_b32 v112, v115 offset:3808
    v_pk_mul_f32 v[90:91], v[88:89], v[84:85] op_sel_hi:[1,0]
    v_pk_fma_f32 v[88:89], v[88:89], v[84:85], v[90:91] op_sel:[1,1,0] op_sel_hi:[0,1,1] neg_lo:[1,0,0]
    v_cvt_pk_bf16_f32 v116, v88, v89
    ds_write_b32 v112, v116 offset:4080
    s_waitcnt vmcnt(0)
    s_cmp_ge_u32 s2, 64
    s_cbranch_scc1 no_uf
    s_lshl_b32 s69, s30, 3
    s_and_b32 s70, s2, 7
    s_add_u32 s69, s69, s70
    s_lshl_b32 s69, s69, 7
    s_lshr_b32 s70, s2, 3
    s_lshl_b32 s70, s70, 2
    s_add_u32 s69, s69, s70
    s_add_u32 s69, s69, 0xe30000
    v_mov_b32 v108, s67
    v_mov_b32 v109, 0
    s_mov_b64 exec, 1
    buffer_store_dword v108, v109, s[40:43], s69 offen sc1
    s_mov_b64 exec, -1
no_uf:
    s_cmp_eq_u32 s68, 0
    s_cbranch_scc1 no_cs1
    v_and_b32 v40, 15, v0
    v_and_b32 v41, 1, v0
    v_lshlrev_b32 v41, 4, v41
    v_mov_b32 v32, 0x3f80
    v_lshlrev_b32 v41, v41, v32
    v_lshrrev_b32 v40, 1, v40
    v_cmp_eq_u32 vcc, 0, v40
    s_nop 1
    v_cndmask_b32 v36, 0, v41, vcc
    v_cmp_eq_u32 vcc, 1, v40
    s_nop 1
    v_cndmask_b32 v37, 0, v41, vcc
    v_cmp_eq_u32 vcc, 2, v40
    s_nop 1
    v_cndmask_b32 v38, 0, v41, vcc
    v_cmp_eq_u32 vcc, 3, v40
    s_nop 1
    v_cndmask_b32 v39, 0, v41, vcc
    s_nop 1
    v_mfma_f32_16x16x32_bf16 v[32:35], v[36:39], v[12:15], 0
    v_mfma_f32_16x16x32_bf16 v[32:35], v[36:39], v[16:19], v[32:35]
    v_mfma_f32_16x16x32_bf16 v[32:35], v[36:39], v[20:23], v[32:35]
    v_mfma_f32_16x16x32_bf16 v[32:35], v[36:39], v[24:27], v[32:35]
    v_mfma_f32_16x16x32_bf16 v[32:35], v[36:39], v[28:31], v[32:35]
    v_and_b32 v40, 3, v0
    v_lshlrev_b32 v40, 5, v40
    v_lshrrev_b32 v41, 4, v0
    v_lshl_add_u32 v40, v41, 4, v40
    s_lshl_b32 s69, s30, 7
    s_add_u32 s69, s69, 161280
    v_add_u32 v40, s69, v40
    s_nop 3
    v_add_f32_dpp v32, v32, v32 row_ror:4 row_mask:0xf bank_mask:0xf
    v_add_f32_dpp v33, v33, v33 row_ror:4 row_mask:0xf bank_mask:0xf
    v_add_f32_dpp v34, v34, v34 row_ror:4 row_mask:0xf bank_mask:0xf
    v_add_f32_dpp v35, v35, v35 row_ror:4 row_mask:0xf bank_mask:0xf
    v_add_f32_dpp v32, v32, v32 row_ror:8 row_mask:0xf bank_mask:0xf
    v_add_f32_dpp v33, v33, v33 row_ror:8 row_mask:0xf bank_mask:0xf
    v_add_f32_dpp v34, v34, v34 row_ror:8 row_mask:0xf bank_mask:0xf
    v_add_f32_dpp v35, v35, v35 row_ror:8 row_mask:0xf bank_mask:0xf
    s_mov_b32 exec_lo, 0x000f000f
    s_mov_b32 exec_hi, 0
    ds_write_b128 v40, v[32:35]
    s_mov_b64 exec, -1
    v_mov_b32 v40, 162304
    v_mov_b32 v41, 1
    s_cmp_eq_u32 s30, 7
    s_cbranch_scc1 cs_last_6
    s_mov_b64 exec, 1
    ds_add_u32 v40, v41
    s_mov_b64 exec, -1
    s_branch cs_done_5
cs_last_6:
    ds_read_b32 v41, v40
    s_waitcnt lgkmcnt(0)
    v_readfirstlane_b32 s69, v41
    s_cmp_lg_u32 s69, 7
    s_cbranch_scc1 cs_last_6
    v_and_b32 v40, 15, v0
    v_lshlrev_b32 v41, 3, v40
    v_add_u32 v41, 161280, v41
    ds_read_b64 v[12:13], v41 offset:0
    ds_read_b64 v[14:15], v41 offset:128
    ds_read_b64 v[16:17], v41 offset:256
    ds_read_b64 v[18:19], v41 offset:384
    ds_read_b64 v[20:21], v41 offset:512
    ds_read_b64 v[22:23], v41 offset:640
    ds_read_b64 v[24:25], v41 offset:768
    ds_read_b64 v[26:27], v41 offset:896
    v_lshlrev_b32 v40, 4, v40
    s_lshl_b32 s69, s65, 8
    s_add_u32 s69, s69, 0x708000
    v_mov_b32 v34, s67
    v_mov_b32 v35, s67
    s_waitcnt lgkmcnt(0)
    v_pk_add_f32 v[32:33], v[12:13], v[14:15]
    v_pk_add_f32 v[32:33], v[32:33], v[16:17]
    v_pk_add_f32 v[32:33], v[32:33], v[18:19]
    v_pk_add_f32 v[32:33], v[32:33], v[20:21]
    v_pk_add_f32 v[32:33], v[32:33], v[22:23]
    v_pk_add_f32 v[32:33], v[32:33], v[24:25]
    v_pk_add_f32 v[32:33], v[32:33], v[26:27]
    s_mov_b64 exec, 0xffff
    buffer_store_dwordx4 v[32:35], v40, s[40:43], s69 offen sc1
    s_mov_b64 exec, -1
cs_done_5:
no_cs1:
    s_setprio 1
    v_pk_mul_f32 v[90:91], v[88:89], v[84:85] op_sel_hi:[1,0]
    v_pk_fma_f32 v[88:89], v[88:89], v[84:85], v[90:91] op_sel:[1,1,0] op_sel_hi:[0,1,1] neg_lo:[1,0,0]
    v_cvt_pk_bf16_f32 v117, v88, v89
    ds_write_b32 v112, v117 offset:4352
    v_pk_mul_f32 v[90:91], v[88:89], v[84:85] op_sel_hi:[1,0]
    v_pk_fma_f32 v[88:89], v[88:89], v[84:85], v[90:91] op_sel:[1,1,0] op_sel_hi:[0,1,1] neg_lo:[1,0,0]
    v_cvt_pk_bf16_f32 v114, v88, v89
    ds_write_b32 v112, v114 offset:4624
    v_pk_mul_f32 v[90:91], v[88:89], v[84:85] op_sel_hi:[1,0]
    v_pk_fma_f32 v[88:89], v[88:89], v[84:85], v[90:91] op_sel:[1,1,0] op_sel_hi:[0,1,1] neg_lo:[1,0,0]
    v_cvt_pk_bf16_f32 v115, v88, v89
    ds_write_b32 v112, v115 offset:4896
    v_pk_mul_f32 v[90:91], v[88:89], v[84:85] op_sel_hi:[1,0]
    v_pk_fma_f32 v[88:89], v[88:89], v[84:85], v[90:91] op_sel:[1,1,0] op_sel_hi:[0,1,1] neg_lo:[1,0,0]
    v_cvt_pk_bf16_f32 v116, v88, v89
    ds_write_b32 v112, v116 offset:5168
    v_pk_mul_f32 v[90:91], v[88:89], v[84:85] op_sel_hi:[1,0]
    v_pk_fma_f32 v[88:89], v[88:89], v[84:85], v[90:91] op_sel:[1,1,0] op_sel_hi:[0,1,1] neg_lo:[1,0,0]
    v_cvt_pk_bf16_f32 v117, v88, v89
    ds_write_b32 v112, v117 offset:5440
    v_pk_mul_f32 v[90:91], v[88:89], v[84:85] op_sel_hi:[1,0]
    v_pk_fma_f32 v[88:89], v[88:89], v[84:85], v[90:91] op_sel:[1,1,0] op_sel_hi:[0,1,1] neg_lo:[1,0,0]
    v_cvt_pk_bf16_f32 v114, v88, v89
    ds_write_b32 v112, v114 offset:5712
    v_pk_mul_f32 v[90:91], v[88:89], v[84:85] op_sel_hi:[1,0]
    v_pk_fma_f32 v[88:89], v[88:89], v[84:85], v[90:91] op_sel:[1,1,0] op_sel_hi:[0,1,1] neg_lo:[1,0,0]
    v_cvt_pk_bf16_f32 v115, v88, v89
    ds_write_b32 v112, v115 offset:5984
    v_pk_mul_f32 v[90:91], v[88:89], v[84:85] op_sel_hi:[1,0]
    v_pk_fma_f32 v[88:89], v[88:89], v[84:85], v[90:91] op_sel:[1,1,0] op_sel_hi:[0,1,1] neg_lo:[1,0,0]
    v_cvt_pk_bf16_f32 v116, v88, v89
    ds_write_b32 v112, v116 offset:6256
    v_pk_mul_f32 v[90:91], v[88:89], v[84:85] op_sel_hi:[1,0]
    v_pk_fma_f32 v[88:89], v[88:89], v[84:85], v[90:91] op_sel:[1,1,0] op_sel_hi:[0,1,1] neg_lo:[1,0,0]
    v_cvt_pk_bf16_f32 v117, v88, v89
    ds_write_b32 v112, v117 offset:6528
    v_pk_mul_f32 v[90:91], v[88:89], v[84:85] op_sel_hi:[1,0]
    v_pk_fma_f32 v[88:89], v[88:89], v[84:85], v[90:91] op_sel:[1,1,0] op_sel_hi:[0,1,1] neg_lo:[1,0,0]
    v_cvt_pk_bf16_f32 v114, v88, v89
    ds_write_b32 v112, v114 offset:6800
    v_pk_mul_f32 v[90:91], v[88:89], v[84:85] op_sel_hi:[1,0]
    v_pk_fma_f32 v[88:89], v[88:89], v[84:85], v[90:91] op_sel:[1,1,0] op_sel_hi:[0,1,1] neg_lo:[1,0,0]
    v_cvt_pk_bf16_f32 v115, v88, v89
    ds_write_b32 v112, v115 offset:7072
    v_pk_mul_f32 v[90:91], v[88:89], v[84:85] op_sel_hi:[1,0]
    v_pk_fma_f32 v[88:89], v[88:89], v[84:85], v[90:91] op_sel:[1,1,0] op_sel_hi:[0,1,1] neg_lo:[1,0,0]
    v_cvt_pk_bf16_f32 v116, v88, v89
    ds_write_b32 v112, v116 offset:7344
    v_pk_mul_f32 v[90:91], v[88:89], v[84:85] op_sel_hi:[1,0]
    v_pk_fma_f32 v[88:89], v[88:89], v[84:85], v[90:91] op_sel:[1,1,0] op_sel_hi:[0,1,1] neg_lo:[1,0,0]
    v_cvt_pk_bf16_f32 v117, v88, v89
    ds_write_b32 v112, v117 offset:7616
    v_pk_mul_f32 v[90:91], v[88:89], v[84:85] op_sel_hi:[1,0]
    v_pk_fma_f32 v[88:89], v[88:89], v[84:85], v[90:91] op_sel:[1,1,0] op_sel_hi:[0,1,1] neg_lo:[1,0,0]
    v_cvt_pk_bf16_f32 v114, v88, v89
    ds_write_b32 v112, v114 offset:7888
    v_pk_mul_f32 v[90:91], v[88:89], v[84:85] op_sel_hi:[1,0]
    v_pk_fma_f32 v[88:89], v[88:89], v[84:85], v[90:91] op_sel:[1,1,0] op_sel_hi:[0,1,1] neg_lo:[1,0,0]
    v_cvt_pk_bf16_f32 v115, v88, v89
    ds_write_b32 v112, v115 offset:8160
    v_pk_mul_f32 v[90:91], v[88:89], v[84:85] op_sel_hi:[1,0]
    v_pk_fma_f32 v[88:89], v[88:89], v[84:85], v[90:91] op_sel:[1,1,0] op_sel_hi:[0,1,1] neg_lo:[1,0,0]
    v_cvt_pk_bf16_f32 v116, v88, v89
    ds_write_b32 v112, v116 offset:8432
    v_cvt_pk_bf16_f32 v117, v92, -v93
    ds_write_b32 v112, v117 offset:8704
    v_pk_mul_f32 v[90:91], v[92:93], v[82:83] op_sel_hi:[1,0]
    v_pk_fma_f32 v[94:95], v[92:93], v[82:83], v[90:91] op_sel:[1,1,0] op_sel_hi:[0,1,1] neg_lo:[1,0,0]
    v_cvt_pk_bf16_f32 v114, v94, -v95
    ds_write_b32 v112, v114 offset:8976
    v_pk_mul_f32 v[90:91], v[94:95], v[82:83] op_sel_hi:[1,0]
    v_pk_fma_f32 v[96:97], v[94:95], v[82:83], v[90:91] op_sel:[1,1,0] op_sel_hi:[0,1,1] neg_lo:[1,0,0]
    v_cvt_pk_bf16_f32 v115, v96, -v97
    ds_write_b32 v112, v115 offset:9248
    v_pk_mul_f32 v[90:91], v[96:97], v[82:83] op_sel_hi:[1,0]
    v_pk_fma_f32 v[98:99], v[96:97], v[82:83], v[90:91] op_sel:[1,1,0] op_sel_hi:[0,1,1] neg_lo:[1,0,0]
    v_cvt_pk_bf16_f32 v116, v98, -v99
    ds_write_b32 v112, v116 offset:9520
    v_pk_mul_f32 v[90:91], v[98:99], v[82:83] op_sel_hi:[1,0]
    v_pk_fma_f32 v[100:101], v[98:99], v[82:83], v[90:91] op_sel:[1,1,0] op_sel_hi:[0,1,1] neg_lo:[1,0,0]
    v_cvt_pk_bf16_f32 v117, v100, -v101
    ds_write_b32 v112, v117 offset:9792
    v_pk_mul_f32 v[90:91], v[100:101], v[82:83] op_sel_hi:[1,0]
    v_pk_fma_f32 v[102:103], v[100:101], v[82:83], v[90:91] op_sel:[1,1,0] op_sel_hi:[0,1,1] neg_lo:[1,0,0]
    v_cvt_pk_bf16_f32 v114, v102, -v103
    ds_write_b32 v112, v114 offset:10064
    v_pk_mul_f32 v[90:91], v[102:103], v[82:83] op_sel_hi:[1,0]
    v_pk_fma_f32 v[104:105], v[102:103], v[82:83], v[90:91] op_sel:[1,1,0] op_sel_hi:[0,1,1] neg_lo:[1,0,0]
    v_cvt_pk_bf16_f32 v115, v104, -v105
    ds_write_b32 v112, v115 offset:10336
    v_pk_mul_f32 v[90:91], v[104:105], v[82:83] op_sel_hi:[1,0]
    v_pk_fma_f32 v[106:107], v[104:105], v[82:83], v[90:91] op_sel:[1,1,0] op_sel_hi:[0,1,1] neg_lo:[1,0,0]
    v_cvt_pk_bf16_f32 v116, v106, -v107
    ds_write_b32 v112, v116 offset:10608
    v_pk_mul_f32 v[90:91], v[92:93], v[86:87] op_sel_hi:[1,0]
    v_pk_fma_f32 v[92:93], v[92:93], v[86:87], v[90:91] op_sel:[1,1,0] op_sel_hi:[0,1,1] neg_lo:[1,0,0]
    v_cvt_pk_bf16_f32 v117, v92, -v93
    ds_write_b32 v112, v117 offset:10880
    v_pk_mul_f32 v[90:91], v[96:97], v[86:87] op_sel_hi:[1,0]
    v_pk_fma_f32 v[96:97], v[96:97], v[86:87], v[90:91] op_sel:[1,1,0] op_sel_hi:[0,1,1] neg_lo:[1,0,0]
    v_cvt_pk_bf16_f32 v114, v96, -v97
    ds_write_b32 v112, v114 offset:11152
    v_pk_mul_f32 v[90:91], v[100:101], v[86:87] op_sel_hi:[1,0]
    v_pk_fma_f32 v[100:101], v[100:101], v[86:87], v[90:91] op_sel:[1,1,0] op_sel_hi:[0,1,1] neg_lo:[1,0,0]
    v_cvt_pk_bf16_f32 v115, v100, -v101
    ds_write_b32 v112, v115 offset:11424
    v_pk_mul_f32 v[90:91], v[104:105], v[86:87] op_sel_hi:[1,0]
    v_pk_fma_f32 v[104:105], v[104:105], v[86:87], v[90:91] op_sel:[1,1,0] op_sel_hi:[0,1,1] neg_lo:[1,0,0]
    v_cvt_pk_bf16_f32 v116, v104, -v105
    ds_write_b32 v112, v116 offset:11696
    v_pk_mul_f32 v[90:91], v[92:93], v[86:87] op_sel_hi:[1,0]
    v_pk_fma_f32 v[92:93], v[92:93], v[86:87], v[90:91] op_sel:[1,1,0] op_sel_hi:[0,1,1] neg_lo:[1,0,0]
    v_cvt_pk_bf16_f32 v117, v92, -v93
    ds_write_b32 v112, v117 offset:11968
    v_pk_mul_f32 v[90:91], v[100:101], v[86:87] op_sel_hi:[1,0]
    v_pk_fma_f32 v[100:101], v[100:101], v[86:87], v[90:91] op_sel:[1,1,0] op_sel_hi:[0,1,1] neg_lo:[1,0,0]
    v_cvt_pk_bf16_f32 v114, v100, -v101
    ds_write_b32 v112, v114 offset:12240
    v_pk_mul_f32 v[90:91], v[92:93], v[86:87] op_sel_hi:[1,0]
    v_pk_fma_f32 v[92:93], v[92:93], v[86:87], v[90:91] op_sel:[1,1,0] op_sel_hi:[0,1,1] neg_lo:[1,0,0]
    v_cvt_pk_bf16_f32 v115, v92, -v93
    ds_write_b32 v112, v115 offset:12512
    v_pk_mul_f32 v[90:91], v[100:101], v[86:87] op_sel_hi:[1,0]
    v_pk_fma_f32 v[100:101], v[100:101], v[86:87], v[90:91] op_sel:[1,1,0] op_sel_hi:[0,1,1] neg_lo:[1,0,0]
    v_cvt_pk_bf16_f32 v116, v100, -v101
    ds_write_b32 v112, v116 offset:12784
    v_pk_mul_f32 v[90:91], v[92:93], v[86:87] op_sel_hi:[1,0]
    v_pk_fma_f32 v[92:93], v[92:93], v[86:87], v[90:91] op_sel:[1,1,0] op_sel_hi:[0,1,1] neg_lo:[1,0,0]
    v_cvt_pk_bf16_f32 v117, v92, -v93
    ds_write_b32 v112, v117 offset:13056
    v_pk_mul_f32 v[90:91], v[92:93], v[86:87] op_sel_hi:[1,0]
    v_pk_fma_f32 v[92:93], v[92:93], v[86:87], v[90:91] op_sel:[1,1,0] op_sel_hi:[0,1,1] neg_lo:[1,0,0]
    v_cvt_pk_bf16_f32 v114, v92, -v93
    ds_write_b32 v112, v114 offset:13328
    v_pk_mul_f32 v[90:91], v[92:93], v[86:87] op_sel_hi:[1,0]
    v_pk_fma_f32 v[92:93], v[92:93], v[86:87], v[90:91] op_sel:[1,1,0] op_sel_hi:[0,1,1] neg_lo:[1,0,0]
    v_cvt_pk_bf16_f32 v115, v92, -v93
    ds_write_b32 v112, v115 offset:13600
    v_pk_mul_f32 v[90:91], v[92:93], v[86:87] op_sel_hi:[1,0]
    v_pk_fma_f32 v[92:93], v[92:93], v[86:87], v[90:91] op_sel:[1,1,0] op_sel_hi:[0,1,1] neg_lo:[1,0,0]
    v_cvt_pk_bf16_f32 v116, v92, -v93
    ds_write_b32 v112, v116 offset:13872
    v_pk_mul_f32 v[90:91], v[92:93], v[86:87] op_sel_hi:[1,0]
    v_pk_fma_f32 v[92:93], v[92:93], v[86:87], v[90:91] op_sel:[1,1,0] op_sel_hi:[0,1,1] neg_lo:[1,0,0]
    v_cvt_pk_bf16_f32 v117, v92, -v93
    ds_write_b32 v112, v117 offset:14144
    s_waitcnt lgkmcnt(0)
    ds_read_b128 v[64:67], v113 offset:8704
    ds_read_b128 v[72:75], v113 offset:0
    ds_read_b128 v[68:71], v113 offset:8736
    ds_read_b128 v[76:79], v113 offset:32
    s_waitcnt lgkmcnt(2)
    v_mfma_f32_32x32x16_bf16 v[48:63], v[64:67], v[72:75], 0
    ds_read_b128 v[64:67], v113 offset:8768
    ds_read_b128 v[72:75], v113 offset:64
    s_waitcnt lgkmcnt(2)
    v_mfma_f32_32x32x16_bf16 v[48:63], v[68:71], v[76:79], v[48:63]
    ds_read_b128 v[68:71], v113 offset:8800
    ds_read_b128 v[76:79], v113 offset:96
    s_waitcnt lgkmcnt(2)
    v_mfma_f32_32x32x16_bf16 v[48:63], v[64:67], v[72:75], v[48:63]
    ds_read_b128 v[64:67], v113 offset:8832
    ds_read_b128 v[72:75], v113 offset:128
    s_waitcnt lgkmcnt(2)
    v_mfma_f32_32x32x16_bf16 v[48:63], v[68:71], v[76:79], v[48:63]
    ds_read_b128 v[68:71], v113 offset:8864
    ds_read_b128 v[76:79], v113 offset:160
    s_waitcnt lgkmcnt(2)
    v_mfma_f32_32x32x16_bf16 v[48:63], v[64:67], v[72:75], v[48:63]
    ds_read_b128 v[64:67], v113 offset:8896
    ds_read_b128 v[72:75], v113 offset:192
    s_waitcnt lgkmcnt(2)
    v_mfma_f32_32x32x16_bf16 v[48:63], v[68:71], v[76:79], v[48:63]
    ds_read_b128 v[68:71], v113 offset:8928
    ds_read_b128 v[76:79], v113 offset:224
    s_waitcnt lgkmcnt(2)
    v_mfma_f32_32x32x16_bf16 v[48:63], v[64:67], v[72:75], v[48:63]
    s_waitcnt lgkmcnt(0)
    v_mfma_f32_32x32x16_bf16 v[48:63], v[68:71], v[76:79], v[48:63]
    s_and_b32 s69, s2, 7
    s_lshl_b32 s69, s69, 10
    s_add_u32 s69, s69, 0xe30000
    v_lshrrev_b32 v108, 3, v0
    v_and_b32 v2, 7, v0
    v_lshlrev_b32 v2, 2, v2
    v_lshl_add_u32 v2, v108, 7, v2
    buffer_load_dword v3, v2, s[40:43], s69 offen sc1
    v_and_b32 v110, 0xffff0000, v4
    v_mul_f32 v108, s52, v110
    v_fma_f32 v109, v110, s52, -v108
    v_fmac_f32 v109, s53, v110
    v_exp_f32 v108, v108
    v_mul_f32 v109, s54, v109
    v_fma_f32 v108, v108, v109, v108
    v_cvt_pk_bf16_f32 v108, v108, v108
    v_lshlrev_b32 v110, 16, v108
    v_mul_f32 v110, v110, v80
    v_mul_f32 v110, s52, v110
    v_and_b32 v111, 0xffff0000, v5
    v_mul_f32 v111, v111, v80
    v_mul_f32 v111, 0.15915494, v111
    v_mul_f32 v108, 0xbf800000, v110
    v_mul_f32 v109, 0x3f800000, v111
    v_exp_f32 v108, v108
    v_fract_f32 v109, v109
    v_cos_f32 v82, v109
    v_sin_f32 v83, v109
    s_nop 0
    v_mul_f32 v82, v82, v108
    v_mul_f32 v83, v83, v108
    v_mul_f32 v108, 0xc1000000, v110
    v_mul_f32 v109, 0x41000000, v111
    v_exp_f32 v108, v108
    v_fract_f32 v109, v109
    v_cos_f32 v84, v109
    v_sin_f32 v85, v109
    s_nop 0
    v_mul_f32 v84, v84, v108
    v_mul_f32 v85, v85, v108
    v_mul_f32 v108, 0xc3800000, v110
    v_mul_f32 v109, 0x43800000, v111
    v_exp_f32 v108, v108
    v_fract_f32 v109, v109
    v_cos_f32 v86, v109
    v_sin_f32 v87, v109
    s_nop 0
    v_mul_f32 v86, v86, v108
    v_mul_f32 v87, v87, v108
    v_and_b32 v92, 0xffff0000, v6
    v_and_b32 v93, 0xffff0000, v7
    v_add_f32 v108, v80, v80
    v_mul_f32 v92, v92, v108
    v_mul_f32 v93, v93, v108
    s_waitcnt lgkmcnt(0)
    v_mov_b32 v117, 0x3f80
    ds_write_b32 v112, v117 offset:0
    v_cvt_pk_bf16_f32 v114, v84, v85
    ds_write_b32 v112, v114 offset:272
    v_pk_mul_f32 v[90:91], v[84:85], v[84:85] op_sel_hi:[1,0]
    v_pk_fma_f32 v[88:89], v[84:85], v[84:85], v[90:91] op_sel:[1,1,0] op_sel_hi:[0,1,1] neg_lo:[1,0,0]
    v_cvt_pk_bf16_f32 v115, v88, v89
    ds_write_b32 v112, v115 offset:544
    v_pk_mul_f32 v[90:91], v[88:89], v[84:85] op_sel_hi:[1,0]
    v_pk_fma_f32 v[88:89], v[88:89], v[84:85], v[90:91] op_sel:[1,1,0] op_sel_hi:[0,1,1] neg_lo:[1,0,0]
    v_cvt_pk_bf16_f32 v116, v88, v89
    ds_write_b32 v112, v116 offset:816
    v_pk_mul_f32 v[90:91], v[88:89], v[84:85] op_sel_hi:[1,0]
    v_pk_fma_f32 v[88:89], v[88:89], v[84:85], v[90:91] op_sel:[1,1,0] op_sel_hi:[0,1,1] neg_lo:[1,0,0]
    v_cvt_pk_bf16_f32 v117, v88, v89
    ds_write_b32 v112, v117 offset:1088
    v_pk_mul_f32 v[90:91], v[88:89], v[84:85] op_sel_hi:[1,0]
    v_pk_fma_f32 v[88:89], v[88:89], v[84:85], v[90:91] op_sel:[1,1,0] op_sel_hi:[0,1,1] neg_lo:[1,0,0]
    v_cvt_pk_bf16_f32 v114, v88, v89
    ds_write_b32 v112, v114 offset:1360
    v_pk_mul_f32 v[90:91], v[88:89], v[84:85] op_sel_hi:[1,0]
    v_pk_fma_f32 v[88:89], v[88:89], v[84:85], v[90:91] op_sel:[1,1,0] op_sel_hi:[0,1,1] neg_lo:[1,0,0]
    v_cvt_pk_bf16_f32 v115, v88, v89
    ds_write_b32 v112, v115 offset:1632
    v_pk_mul_f32 v[90:91], v[88:89], v[84:85] op_sel_hi:[1,0]
    v_pk_fma_f32 v[88:89], v[88:89], v[84:85], v[90:91] op_sel:[1,1,0] op_sel_hi:[0,1,1] neg_lo:[1,0,0]
    v_cvt_pk_bf16_f32 v116, v88, v89
    ds_write_b32 v112, v116 offset:1904
    v_pk_mul_f32 v[90:91], v[88:89], v[84:85] op_sel_hi:[1,0]
    v_pk_fma_f32 v[88:89], v[88:89], v[84:85], v[90:91] op_sel:[1,1,0] op_sel_hi:[0,1,1] neg_lo:[1,0,0]
    v_cvt_pk_bf16_f32 v117, v88, v89
    ds_write_b32 v112, v117 offset:2176
    v_pk_mul_f32 v[90:91], v[88:89], v[84:85] op_sel_hi:[1,0]
    v_pk_fma_f32 v[88:89], v[88:89], v[84:85], v[90:91] op_sel:[1,1,0] op_sel_hi:[0,1,1] neg_lo:[1,0,0]
    v_cvt_pk_bf16_f32 v114, v88, v89
    ds_write_b32 v112, v114 offset:2448
    v_pk_mul_f32 v[90:91], v[88:89], v[84:85] op_sel_hi:[1,0]
    v_pk_fma_f32 v[88:89], v[88:89], v[84:85], v[90:91] op_sel:[1,1,0] op_sel_hi:[0,1,1] neg_lo:[1,0,0]
    v_cvt_pk_bf16_f32 v115, v88, v89
    ds_write_b32 v112, v115 offset:2720
    v_pk_mul_f32 v[90:91], v[88:89], v[84:85] op_sel_hi:[1,0]
    v_pk_fma_f32 v[88:89], v[88:89], v[84:85], v[90:91] op_sel:[1,1,0] op_sel_hi:[0,1,1] neg_lo:[1,0,0]
    v_cvt_pk_bf16_f32 v116, v88, v89
    ds_write_b32 v112, v116 offset:2992
    v_pk_mul_f32 v[90:91], v[88:89], v[84:85] op_sel_hi:[1,0]
    v_pk_fma_f32 v[88:89], v[88:89], v[84:85], v[90:91] op_sel:[1,1,0] op_sel_hi:[0,1,1] neg_lo:[1,0,0]
    v_cvt_pk_bf16_f32 v117, v88, v89
    ds_write_b32 v112, v117 offset:3264
    v_pk_mul_f32 v[90:91], v[88:89], v[84:85] op_sel_hi:[1,0]
    v_pk_fma_f32 v[88:89], v[88:89], v[84:85], v[90:91] op_sel:[1,1,0] op_sel_hi:[0,1,1] neg_lo:[1,0,0]
    v_cvt_pk_bf16_f32 v114, v88, v89
    ds_write_b32 v112, v114 offset:3536
    v_pk_mul_f32 v[90:91], v[88:89], v[84:85] op_sel_hi:[1,0]
    v_pk_fma_f32 v[88:89], v[88:89], v[84:85], v[90:91] op_sel:[1,1,0] op_sel_hi:[0,1,1] neg_lo:[1,0,0]
    v_cvt_pk_bf16_f32 v115, v88, v89
    ds_write_b32 v112, v115 offset:3808
    v_pk_mul_f32 v[90:91], v[88:89], v[84:85] op_sel_hi:[1,0]
    v_pk_fma_f32 v[88:89], v[88:89], v[84:85], v[90:91] op_sel:[1,1,0] op_sel_hi:[0,1,1] neg_lo:[1,0,0]
    v_cvt_pk_bf16_f32 v116, v88, v89
    ds_write_b32 v112, v116 offset:4080
    v_pk_mul_f32 v[90:91], v[88:89], v[84:85] op_sel_hi:[1,0]
    v_pk_fma_f32 v[88:89], v[88:89], v[84:85], v[90:91] op_sel:[1,1,0] op_sel_hi:[0,1,1] neg_lo:[1,0,0]
    v_cvt_pk_bf16_f32 v117, v88, v89
    ds_write_b32 v112, v117 offset:4352
    v_pk_mul_f32 v[90:91], v[88:89], v[84:85] op_sel_hi:[1,0]
    v_pk_fma_f32 v[88:89], v[88:89], v[84:85], v[90:91] op_sel:[1,1,0] op_sel_hi:[0,1,1] neg_lo:[1,0,0]
    v_cvt_pk_bf16_f32 v114, v88, v89
    ds_write_b32 v112, v114 offset:4624
    v_pk_mul_f32 v[90:91], v[88:89], v[84:85] op_sel_hi:[1,0]
    v_pk_fma_f32 v[88:89], v[88:89], v[84:85], v[90:91] op_sel:[1,1,0] op_sel_hi:[0,1,1] neg_lo:[1,0,0]
    v_cvt_pk_bf16_f32 v115, v88, v89
    ds_write_b32 v112, v115 offset:4896
    v_pk_mul_f32 v[90:91], v[88:89], v[84:85] op_sel_hi:[1,0]
    v_pk_fma_f32 v[88:89], v[88:89], v[84:85], v[90:91] op_sel:[1,1,0] op_sel_hi:[0,1,1] neg_lo:[1,0,0]
    v_cvt_pk_bf16_f32 v116, v88, v89
    ds_write_b32 v112, v116 offset:5168
    v_pk_mul_f32 v[90:91], v[88:89], v[84:85] op_sel_hi:[1,0]
    v_pk_fma_f32 v[88:89], v[88:89], v[84:85], v[90:91] op_sel:[1,1,0] op_sel_hi:[0,1,1] neg_lo:[1,0,0]
    v_cvt_pk_bf16_f32 v117, v88, v89
    ds_write_b32 v112, v117 offset:5440
    v_pk_mul_f32 v[90:91], v[88:89], v[84:85] op_sel_hi:[1,0]
    v_pk_fma_f32 v[88:89], v[88:89], v[84:85], v[90:91] op_sel:[1,1,0] op_sel_hi:[0,1,1] neg_lo:[1,0,0]
    v_cvt_pk_bf16_f32 v114, v88, v89
    ds_write_b32 v112, v114 offset:5712
    v_pk_mul_f32 v[90:91], v[88:89], v[84:85] op_sel_hi:[1,0]
    v_pk_fma_f32 v[88:89], v[88:89], v[84:85], v[90:91] op_sel:[1,1,0] op_sel_hi:[0,1,1] neg_lo:[1,0,0]
    v_cvt_pk_bf16_f32 v115, v88, v89
    ds_write_b32 v112, v115 offset:5984
    v_pk_mul_f32 v[90:91], v[88:89], v[84:85] op_sel_hi:[1,0]
    v_pk_fma_f32 v[88:89], v[88:89], v[84:85], v[90:91] op_sel:[1,1,0] op_sel_hi:[0,1,1] neg_lo:[1,0,0]
    v_cvt_pk_bf16_f32 v116, v88, v89
    ds_write_b32 v112, v116 offset:6256
    v_pk_mul_f32 v[90:91], v[88:89], v[84:85] op_sel_hi:[1,0]
    v_pk_fma_f32 v[88:89], v[88:89], v[84:85], v[90:91] op_sel:[1,1,0] op_sel_hi:[0,1,1] neg_lo:[1,0,0]
    v_cvt_pk_bf16_f32 v117, v88, v89
    ds_write_b32 v112, v117 offset:6528
    v_pk_mul_f32 v[90:91], v[88:89], v[84:85] op_sel_hi:[1,0]
    v_pk_fma_f32 v[88:89], v[88:89], v[84:85], v[90:91] op_sel:[1,1,0] op_sel_hi:[0,1,1] neg_lo:[1,0,0]
    v_cvt_pk_bf16_f32 v114, v88, v89
    ds_write_b32 v112, v114 offset:6800
    v_pk_mul_f32 v[90:91], v[88:89], v[84:85] op_sel_hi:[1,0]
    v_pk_fma_f32 v[88:89], v[88:89], v[84:85], v[90:91] op_sel:[1,1,0] op_sel_hi:[0,1,1] neg_lo:[1,0,0]
    v_cvt_pk_bf16_f32 v115, v88, v89
    ds_write_b32 v112, v115 offset:7072
    v_pk_mul_f32 v[90:91], v[88:89], v[84:85] op_sel_hi:[1,0]
    v_pk_fma_f32 v[88:89], v[88:89], v[84:85], v[90:91] op_sel:[1,1,0] op_sel_hi:[0,1,1] neg_lo:[1,0,0]
    v_cvt_pk_bf16_f32 v116, v88, v89
    ds_write_b32 v112, v116 offset:7344
    v_pk_mul_f32 v[90:91], v[88:89], v[84:85] op_sel_hi:[1,0]
    v_pk_fma_f32 v[88:89], v[88:89], v[84:85], v[90:91] op_sel:[1,1,0] op_sel_hi:[0,1,1] neg_lo:[1,0,0]
    v_cvt_pk_bf16_f32 v117, v88, v89
    ds_write_b32 v112, v117 offset:7616
    v_pk_mul_f32 v[90:91], v[88:89], v[84:85] op_sel_hi:[1,0]
    v_pk_fma_f32 v[88:89], v[88:89], v[84:85], v[90:91] op_sel:[1,1,0] op_sel_hi:[0,1,1] neg_lo:[1,0,0]
    v_cvt_pk_bf16_f32 v114, v88, v89
    ds_write_b32 v112, v114 offset:7888
    v_pk_mul_f32 v[90:91], v[88:89], v[84:85] op_sel_hi:[1,0]
    v_pk_fma_f32 v[88:89], v[88:89], v[84:85], v[90:91] op_sel:[1,1,0] op_sel_hi:[0,1,1] neg_lo:[1,0,0]
    v_cvt_pk_bf16_f32 v115, v88, v89
    ds_write_b32 v112, v115 offset:8160
    v_pk_mul_f32 v[90:91], v[88:89], v[84:85] op_sel_hi:[1,0]
    v_pk_fma_f32 v[88:89], v[88:89], v[84:85], v[90:91] op_sel:[1,1,0] op_sel_hi:[0,1,1] neg_lo:[1,0,0]
    v_cvt_pk_bf16_f32 v116, v88, v89
    ds_write_b32 v112, v116 offset:8432
    s_waitcnt vmcnt(0)
    v_cmp_ne_u32 vcc, s67, v3
    s_mov_b32 s71, 0
    s_cbranch_vccnz u_later
    s_mul_i32 s70, s30, 4576
    s_add_u32 m0, s70, 127456
    s_lshl_b32 s70, s60, 6
    s_add_u32 s70, s70, 0xb00000
    v_lshrrev_b32 v108, 2, v0
    v_mul_u32_u24 v108, 41344, v108
    v_and_b32 v3, 3, v0
    v_lshl_add_u32 v108, v3, 4, v108
    buffer_load_dwordx4 v108, s[40:43], s70 offen offset:0 sc1 lds
    s_add_u32 s70, s70, 660480
    buffer_load_dwordx4 v108, s[40:43], s70 offen offset:1024 sc1 lds
    s_add_u32 s70, s70, 660480
    buffer_load_dwordx4 v108, s[40:43], s70 offen offset:2048 sc1 lds
    s_add_u32 s70, s70, 660480
    buffer_load_dwordx4 v108, s[40:43], s70 offen offset:3072 sc1 lds
    s_mov_b32 s71, 1
    s_branch u_l1
u_later:
    buffer_load_dword v3, v2, s[40:43], s69 offen sc1
u_l1:
    v_cvt_pk_bf16_f32 v117, v92, -v93
    ds_write_b32 v112, v117 offset:8704
    v_pk_mul_f32 v[90:91], v[92:93], v[82:83] op_sel_hi:[1,0]
    v_pk_fma_f32 v[94:95], v[92:93], v[82:83], v[90:91] op_sel:[1,1,0] op_sel_hi:[0,1,1] neg_lo:[1,0,0]
    v_cvt_pk_bf16_f32 v114, v94, -v95
    ds_write_b32 v112, v114 offset:8976
    v_pk_mul_f32 v[90:91], v[94:95], v[82:83] op_sel_hi:[1,0]
    v_pk_fma_f32 v[96:97], v[94:95], v[82:83], v[90:91] op_sel:[1,1,0] op_sel_hi:[0,1,1] neg_lo:[1,0,0]
    v_cvt_pk_bf16_f32 v115, v96, -v97
    ds_write_b32 v112, v115 offset:9248
    v_pk_mul_f32 v[90:91], v[96:97], v[82:83] op_sel_hi:[1,0]
    v_pk_fma_f32 v[98:99], v[96:97], v[82:83], v[90:91] op_sel:[1,1,0] op_sel_hi:[0,1,1] neg_lo:[1,0,0]
    v_cvt_pk_bf16_f32 v116, v98, -v99
    ds_write_b32 v112, v116 offset:9520
    v_pk_mul_f32 v[90:91], v[98:99], v[82:83] op_sel_hi:[1,0]
    v_pk_fma_f32 v[100:101], v[98:99], v[82:83], v[90:91] op_sel:[1,1,0] op_sel_hi:[0,1,1] neg_lo:[1,0,0]
    v_cvt_pk_bf16_f32 v117, v100, -v101
    ds_write_b32 v112, v117 offset:9792
    v_pk_mul_f32 v[90:91], v[100:101], v[82:83] op_sel_hi:[1,0]
    v_pk_fma_f32 v[102:103], v[100:101], v[82:83], v[90:91] op_sel:[1,1,0] op_sel_hi:[0,1,1] neg_lo:[1,0,0]
    v_cvt_pk_bf16_f32 v114, v102, -v103
    ds_write_b32 v112, v114 offset:10064
    v_pk_mul_f32 v[90:91], v[102:103], v[82:83] op_sel_hi:[1,0]
    v_pk_fma_f32 v[104:105], v[102:103], v[82:83], v[90:91] op_sel:[1,1,0] op_sel_hi:[0,1,1] neg_lo:[1,0,0]
    v_cvt_pk_bf16_f32 v115, v104, -v105
    ds_write_b32 v112, v115 offset:10336
    v_pk_mul_f32 v[90:91], v[104:105], v[82:83] op_sel_hi:[1,0]
    v_pk_fma_f32 v[106:107], v[104:105], v[82:83], v[90:91] op_sel:[1,1,0] op_sel_hi:[0,1,1] neg_lo:[1,0,0]
    v_cvt_pk_bf16_f32 v116, v106, -v107
    ds_write_b32 v112, v116 offset:10608
    v_pk_mul_f32 v[90:91], v[92:93], v[86:87] op_sel_hi:[1,0]
    v_pk_fma_f32 v[92:93], v[92:93], v[86:87], v[90:91] op_sel:[1,1,0] op_sel_hi:[0,1,1] neg_lo:[1,0,0]
    v_cvt_pk_bf16_f32 v117, v92, -v93
    ds_write_b32 v112, v117 offset:10880
    v_pk_mul_f32 v[90:91], v[96:97], v[86:87] op_sel_hi:[1,0]
    v_pk_fma_f32 v[96:97], v[96:97], v[86:87], v[90:91] op_sel:[1,1,0] op_sel_hi:[0,1,1] neg_lo:[1,0,0]
    v_cvt_pk_bf16_f32 v114, v96, -v97
    ds_write_b32 v112, v114 offset:11152
    v_pk_mul_f32 v[90:91], v[100:101], v[86:87] op_sel_hi:[1,0]
    v_pk_fma_f32 v[100:101], v[100:101], v[86:87], v[90:91] op_sel:[1,1,0] op_sel_hi:[0,1,1] neg_lo:[1,0,0]
    v_cvt_pk_bf16_f32 v115, v100, -v101
    ds_write_b32 v112, v115 offset:11424
    v_pk_mul_f32 v[90:91], v[104:105], v[86:87] op_sel_hi:[1,0]
    v_pk_fma_f32 v[104:105], v[104:105], v[86:87], v[90:91] op_sel:[1,1,0] op_sel_hi:[0,1,1] neg_lo:[1,0,0]
    v_cvt_pk_bf16_f32 v116, v104, -v105
    ds_write_b32 v112, v116 offset:11696
    v_pk_mul_f32 v[90:91], v[92:93], v[86:87] op_sel_hi:[1,0]
    v_pk_fma_f32 v[92:93], v[92:93], v[86:87], v[90:91] op_sel:[1,1,0] op_sel_hi:[0,1,1] neg_lo:[1,0,0]
    v_cvt_pk_bf16_f32 v117, v92, -v93
    ds_write_b32 v112, v117 offset:11968
    v_pk_mul_f32 v[90:91], v[100:101], v[86:87] op_sel_hi:[1,0]
    v_pk_fma_f32 v[100:101], v[100:101], v[86:87], v[90:91] op_sel:[1,1,0] op_sel_hi:[0,1,1] neg_lo:[1,0,0]
    v_cvt_pk_bf16_f32 v114, v100, -v101
    ds_write_b32 v112, v114 offset:12240
    v_pk_mul_f32 v[90:91], v[92:93], v[86:87] op_sel_hi:[1,0]
    v_pk_fma_f32 v[92:93], v[92:93], v[86:87], v[90:91] op_sel:[1,1,0] op_sel_hi:[0,1,1] neg_lo:[1,0,0]
    v_cvt_pk_bf16_f32 v115, v92, -v93
    ds_write_b32 v112, v115 offset:12512
    v_pk_mul_f32 v[90:91], v[100:101], v[86:87] op_sel_hi:[1,0]
    v_pk_fma_f32 v[100:101], v[100:101], v[86:87], v[90:91] op_sel:[1,1,0] op_sel_hi:[0,1,1] neg_lo:[1,0,0]
    v_cvt_pk_bf16_f32 v116, v100, -v101
    ds_write_b32 v112, v116 offset:12784
    v_pk_mul_f32 v[90:91], v[92:93], v[86:87] op_sel_hi:[1,0]
    v_pk_fma_f32 v[92:93], v[92:93], v[86:87], v[90:91] op_sel:[1,1,0] op_sel_hi:[0,1,1] neg_lo:[1,0,0]
    v_cvt_pk_bf16_f32 v117, v92, -v93
    ds_write_b32 v112, v117 offset:13056
    v_pk_mul_f32 v[90:91], v[92:93], v[86:87] op_sel_hi:[1,0]
    v_pk_fma_f32 v[92:93], v[92:93], v[86:87], v[90:91] op_sel:[1,1,0] op_sel_hi:[0,1,1] neg_lo:[1,0,0]
    v_cvt_pk_bf16_f32 v114, v92, -v93
    ds_write_b32 v112, v114 offset:13328
    v_pk_mul_f32 v[90:91], v[92:93], v[86:87] op_sel_hi:[1,0]
    v_pk_fma_f32 v[92:93], v[92:93], v[86:87], v[90:91] op_sel:[1,1,0] op_sel_hi:[0,1,1] neg_lo:[1,0,0]
    v_cvt_pk_bf16_f32 v115, v92, -v93
    ds_write_b32 v112, v115 offset:13600
    v_pk_mul_f32 v[90:91], v[92:93], v[86:87] op_sel_hi:[1,0]
    v_pk_fma_f32 v[92:93], v[92:93], v[86:87], v[90:91] op_sel:[1,1,0] op_sel_hi:[0,1,1] neg_lo:[1,0,0]
    v_cvt_pk_bf16_f32 v116, v92, -v93
    ds_write_b32 v112, v116 offset:13872
    v_pk_mul_f32 v[90:91], v[92:93], v[86:87] op_sel_hi:[1,0]
    v_pk_fma_f32 v[92:93], v[92:93], v[86:87], v[90:91] op_sel:[1,1,0] op_sel_hi:[0,1,1] neg_lo:[1,0,0]
    v_cvt_pk_bf16_f32 v117, v92, -v93
    ds_write_b32 v112, v117 offset:14144
    s_waitcnt lgkmcnt(0)
    ds_read_b128 v[64:67], v113 offset:8704
    ds_read_b128 v[72:75], v113 offset:0
    ds_read_b128 v[68:71], v113 offset:8736
    ds_read_b128 v[76:79], v113 offset:32
    s_waitcnt lgkmcnt(2)
    v_mfma_f32_32x32x16_bf16 v[48:63], v[64:67], v[72:75], v[48:63]
    ds_read_b128 v[64:67], v113 offset:8768
    ds_read_b128 v[72:75], v113 offset:64
    s_waitcnt lgkmcnt(2)
    v_mfma_f32_32x32x16_bf16 v[48:63], v[68:71], v[76:79], v[48:63]
    ds_read_b128 v[68:71], v113 offset:8800
    ds_read_b128 v[76:79], v113 offset:96
    s_waitcnt lgkmcnt(2)
    v_mfma_f32_32x32x16_bf16 v[48:63], v[64:67], v[72:75], v[48:63]
    ds_read_b128 v[64:67], v113 offset:8832
    ds_read_b128 v[72:75], v113 offset:128
    s_waitcnt lgkmcnt(2)
    v_mfma_f32_32x32x16_bf16 v[48:63], v[68:71], v[76:79], v[48:63]
    ds_read_b128 v[68:71], v113 offset:8864
    ds_read_b128 v[76:79], v113 offset:160
    s_waitcnt lgkmcnt(2)
    v_mfma_f32_32x32x16_bf16 v[48:63], v[64:67], v[72:75], v[48:63]
    ds_read_b128 v[64:67], v113 offset:8896
    ds_read_b128 v[72:75], v113 offset:192
    s_waitcnt lgkmcnt(2)
    v_mfma_f32_32x32x16_bf16 v[48:63], v[68:71], v[76:79], v[48:63]
    ds_read_b128 v[68:71], v113 offset:8928
    ds_read_b128 v[76:79], v113 offset:224
    s_waitcnt lgkmcnt(2)
    v_mfma_f32_32x32x16_bf16 v[48:63], v[64:67], v[72:75], v[48:63]
    s_waitcnt lgkmcnt(0)
    v_mfma_f32_32x32x16_bf16 v[48:63], v[68:71], v[76:79], v[48:63]
    s_cmp_eq_u32 s71, 1
    s_cbranch_scc1 u_l2
    s_waitcnt vmcnt(0)
    v_cmp_ne_u32 vcc, s67, v3
    s_cbranch_vccnz u_l2
    s_mul_i32 s70, s30, 4576
    s_add_u32 m0, s70, 127456
    s_lshl_b32 s70, s60, 6
    s_add_u32 s70, s70, 0xb00000
    v_lshrrev_b32 v108, 2, v0
    v_mul_u32_u24 v108, 41344, v108
    v_and_b32 v3, 3, v0
    v_lshl_add_u32 v108, v3, 4, v108
    buffer_load_dwordx4 v108, s[40:43], s70 offen offset:0 sc1 lds
    s_add_u32 s70, s70, 660480
    buffer_load_dwordx4 v108, s[40:43], s70 offen offset:1024 sc1 lds
    s_add_u32 s70, s70, 660480
    buffer_load_dwordx4 v108, s[40:43], s70 offen offset:2048 sc1 lds
    s_add_u32 s70, s70, 660480
    buffer_load_dwordx4 v108, s[40:43], s70 offen offset:3072 sc1 lds
    s_mov_b32 s71, 1
u_l2:
    v_and_b32 v108, 31, v0
    v_lshrrev_b32 v109, 5, v0
    s_add_u32 s56, s55, 12800
    v_lshlrev_b32 v114, 5, v108
    v_lshl_add_u32 v114, v109, 4, v114
    v_add_u32 v114, s56, v114
    v_cmp_eq_u32 vcc, 0, v109
    v_lshlrev_b32 v110, 4, v108
    v_lshlrev_b32 v111, 3, v108
    v_add_u32 v110, 1024, v110
    v_add_u32 v111, 1536, v111
    v_cndmask_b32 v115, v111, v110, vcc
    v_add_u32 v110, 8, v110
    v_add_u32 v111, 256, v111
    v_cndmask_b32 v116, v111, v110, vcc
    v_add_u32 v115, s56, v115
    v_add_u32 v116, s56, v116
    v_lshlrev_b32 v117, 2, v108
    v_lshl_add_u32 v117, v109, 9, v117
    v_add_u32 v117, s56, v117
    s_mov_b64 exec, 1
    v_add_f32 v48, s62, v48
    s_mov_b64 exec, -1
    ds_write_b128 v114, v[48:51]
    ds_write_b64 v115, v[52:53]
    ds_write_b64 v116, v[54:55]
    ds_write_b32 v117, v56 offset:2048
    ds_write_b32 v117, v57 offset:2176
    ds_write_b32 v117, v58 offset:2304
    ds_write_b32 v117, v59 offset:2432
    v_and_b32 v108, 15, v0
    v_lshrrev_b32 v109, 4, v0
    v_lshlrev_b32 v114, 6, v108
    v_lshl_add_u32 v114, v109, 4, v114
    v_add_u32 v114, s56, v114
    v_lshlrev_b32 v115, 5, v108
    v_lshl_add_u32 v115, v109, 3, v115
    v_add_u32 v115, s56, v115
    v_and_b32 v110, 31, v0
    v_lshrrev_b32 v111, 5, v0
    v_lshlrev_b32 v116, 4, v110
    v_lshl_add_u32 v116, v111, 3, v116
    v_add_u32 v116, s56, v116
    v_lshlrev_b32 v117, 3, v0
    v_add_u32 v117, s56, v117
    v_mov_b32 v113, s56
    s_waitcnt lgkmcnt(0)
    ds_read_b128 v[48:51], v114
    ds_read_b128 v[52:55], v114 offset:16
    ds_read_b64 v[56:57], v115 offset:1024
    ds_read_b64 v[58:59], v115 offset:1032
    ds_read_b64 v[60:61], v116 offset:1536
    ds_read_b32 v62, v116 offset:1544
    ds_read_b64 v[64:65], v117 offset:2048
    ds_read_b32 v66, v117 offset:2056
    ds_read_b128 v[68:71], v113
    v_mul_u32_u24 v114, 2112, v109
    v_lshl_add_u32 v114, v108, 3, v114
    v_add_u32 v114, s55, v114
    v_mul_u32_u24 v116, 4224, v111
    v_lshl_add_u32 v116, v110, 3, v116
    v_add_u32 v116, s55, v116
    v_lshlrev_b32 v117, 3, v0
    v_add_u32 v117, s55, v117
    v_mul_u32_u24 v115, 528, v108
    v_add_u32 v115, s55, v115
    v_cmp_eq_u32 vcc, 63, v0
    s_waitcnt lgkmcnt(0)
    s_nop 1
    v_cndmask_b32 v54, v54, v53, vcc
    v_cndmask_b32 v53, v53, v52, vcc
    v_cndmask_b32 v59, v59, v58, vcc
    v_cvt_pk_bf16_f32 v92, v51, v50
    v_cvt_pk_bf16_f32 v93, v49, v48
    ds_write_b64 v114, v[92:93] offset:8
    v_cvt_pk_bf16_f32 v94, v52, v51
    v_cvt_pk_bf16_f32 v95, v50, v49
    ds_write_b64 v114, v[94:95] offset:536
    v_cvt_pk_bf16_f32 v96, v53, v52
    v_cvt_pk_bf16_f32 v97, v51, v50
    ds_write_b64 v114, v[96:97] offset:1064
    v_cvt_pk_bf16_f32 v98, v54, v53
    v_cvt_pk_bf16_f32 v99, v52, v51
    ds_write_b64 v114, v[98:99] offset:1592
    v_cvt_pk_bf16_f32 v100, v58, v57
    v_cvt_pk_bf16_f32 v101, v56, v56
    ds_write_b64 v114, v[100:101] offset:136
    v_cvt_pk_bf16_f32 v102, v58, v58
    v_cvt_pk_bf16_f32 v103, v57, v56
    ds_write_b64 v114, v[102:103] offset:664
    v_cvt_pk_bf16_f32 v104, v58, v58
    v_cvt_pk_bf16_f32 v105, v58, v57
    ds_write_b64 v114, v[104:105] offset:1192
    v_cvt_pk_bf16_f32 v106, v59, v58
    v_cvt_pk_bf16_f32 v107, v58, v58
    ds_write_b64 v114, v[106:107] offset:1720
    v_cvt_pk_bf16_f32 v82, v61, v60
    v_cvt_pk_bf16_f32 v83, v60, v60
    ds_write_b64 v116, v[82:83] offset:264
    v_cvt_pk_bf16_f32 v84, v61, v61
    v_cvt_pk_bf16_f32 v85, v60, v60
    ds_write_b64 v116, v[84:85] offset:792
    v_cvt_pk_bf16_f32 v86, v61, v61
    v_cvt_pk_bf16_f32 v87, v61, v60
    ds_write_b64 v116, v[86:87] offset:1320
    v_cvt_pk_bf16_f32 v88, v62, v61
    v_cvt_pk_bf16_f32 v89, v61, v61
    ds_write_b64 v116, v[88:89] offset:1848
    v_cvt_pk_bf16_f32 v92, v62, v62
    v_cvt_pk_bf16_f32 v93, v61, v61
    ds_write_b64 v116, v[92:93] offset:2376
    v_cvt_pk_bf16_f32 v94, v62, v62
    v_cvt_pk_bf16_f32 v95, v62, v61
    ds_write_b64 v116, v[94:95] offset:2904
    v_cvt_pk_bf16_f32 v96, v62, v62
    v_cvt_pk_bf16_f32 v97, v62, v62
    ds_write_b64 v116, v[96:97] offset:3432
    ds_write_b64 v116, v[96:97] offset:3960
    v_cvt_pk_bf16_f32 v98, v64, v64
    v_cvt_pk_bf16_f32 v99, v64, v64
    ds_write_b64 v117, v[98:99] offset:8448
    v_cvt_pk_bf16_f32 v100, v65, v64
    v_cvt_pk_bf16_f32 v101, v64, v64
    ds_write_b64 v117, v[100:101] offset:8992
    v_cvt_pk_bf16_f32 v102, v65, v65
    v_cvt_pk_bf16_f32 v103, v64, v64
    ds_write_b64 v117, v[102:103] offset:9536
    v_cvt_pk_bf16_f32 v104, v65, v65
    v_cvt_pk_bf16_f32 v105, v65, v64
    ds_write_b64 v117, v[104:105] offset:10080
    v_cvt_pk_bf16_f32 v106, v65, v65
    v_cvt_pk_bf16_f32 v107, v65, v65
    ds_write_b64 v117, v[106:107] offset:10624
    v_cvt_pk_bf16_f32 v82, v66, v65
    v_cvt_pk_bf16_f32 v83, v65, v65
    ds_write_b64 v117, v[82:83] offset:11168
    v_cvt_pk_bf16_f32 v84, v66, v66
    v_cvt_pk_bf16_f32 v85, v65, v65
    ds_write_b64 v117, v[84:85] offset:11712
    v_cvt_pk_bf16_f32 v86, v66, v66
    v_cvt_pk_bf16_f32 v87, v66, v65
    ds_write_b64 v117, v[86:87] offset:12256
    v_cvt_pk_bf16_f32 v88, v66, v66
    v_cvt_pk_bf16_f32 v89, v66, v66
    ds_write_b64 v117, v[88:89] offset:8456
    v_mov_b32 v71, 0
    v_cvt_pk_bf16_f32 v110, v68, v71
    v_cvt_pk_bf16_f32 v111, v69, v68
    v_cvt_pk_bf16_f32 v69, v70, v69
    v_cmp_eq_u32 vcc, 13, v108
    s_nop 1
    v_cndmask_b32 v90, 0, v110, vcc
    v_cmp_eq_u32 vcc, 14, v108
    s_nop 1
    v_cndmask_b32 v90, v90, v111, vcc
    v_cmp_eq_u32 vcc, 15, v108
    s_nop 1
    v_cndmask_b32 v90, v90, v69, vcc
    v_cndmask_b32 v91, 0, v110, vcc
    ds_write_b64 v115, v[90:91]
    s_cmp_eq_u32 s71, 1
    s_cbranch_scc1 u_done
u_poll:
    buffer_load_dword v3, v2, s[40:43], s69 offen sc1
    s_waitcnt vmcnt(0)
    v_cmp_ne_u32 vcc, s67, v3
    s_cbranch_vccnz u_poll
    s_mul_i32 s70, s30, 4576
    s_add_u32 m0, s70, 127456
    s_lshl_b32 s70, s60, 6
    s_add_u32 s70, s70, 0xb00000
    v_lshrrev_b32 v1, 2, v0
    v_mul_u32_u24 v1, 41344, v1
    v_and_b32 v3, 3, v0
    v_lshl_add_u32 v1, v3, 4, v1
    buffer_load_dwordx4 v1, s[40:43], s70 offen offset:0 sc1 lds
    s_add_u32 s70, s70, 660480
    buffer_load_dwordx4 v1, s[40:43], s70 offen offset:1024 sc1 lds
    s_add_u32 s70, s70, 660480
    buffer_load_dwordx4 v1, s[40:43], s70 offen offset:2048 sc1 lds
    s_add_u32 s70, s70, 660480
    buffer_load_dwordx4 v1, s[40:43], s70 offen offset:3072 sc1 lds
    s_waitcnt vmcnt(0)
u_done:
    s_mul_i32 s52, s30, 15872
    s_mov_b32 s53, 0x44432100
    v_and_b32 v216, 15, v0
    v_lshrrev_b32 v217, 4, v0
    v_mov_b32 v220, 0x7654
    v_lshlrev_b32 v218, 3, v217
    v_sub_u32 v218, v216, v218
    v_add_u32 v218, 29, v218
    v_lshrrev_b32 v219, 4, v218
    v_and_b32 v218, 15, v218
    v_mul_u32_u24 v208, 528, v218
    v_lshl_add_u32 v208, v219, 3, v208
    v_add_u32 v208, s52, v208
    v_cmp_gt_u32 vcc, 8, v218
    v_mov_b32 v212, s53
    v_and_b32 v210, 7, v218
    v_cndmask_b32 v212, v220, v212, vcc
    v_lshlrev_b32 v210, 2, v210
    v_bfe_u32 v210, v212, v210, 4
    v_mul_u32_u24 v210, 544, v210
    v_cmp_lt_u32 vcc, 11, v218
    v_lshl_add_u32 v210, v219, 3, v210
    v_add_u32 v210, s52, v210
    v_cndmask_b32 v218, 0, 8, vcc
    v_add_u32 v210, 8440, v210
    v_add_u32 v210, v218, v210
    v_cmp_eq_u32 vcc, 0, v219
    v_add_u32 v218, 512, v208
    s_nop 0
    v_cndmask_b32 v212, v210, v218, vcc
    v_lshlrev_b32 v218, 3, v217
    v_sub_u32 v218, v216, v218
    v_add_u32 v218, 25, v218
    v_lshrrev_b32 v219, 4, v218
    v_and_b32 v218, 15, v218
    v_mul_u32_u24 v209, 528, v218
    v_lshl_add_u32 v209, v219, 3, v209
    v_add_u32 v209, s52, v209
    v_cmp_gt_u32 vcc, 8, v218
    v_mov_b32 v213, s53
    v_and_b32 v211, 7, v218
    v_cndmask_b32 v213, v220, v213, vcc
    v_lshlrev_b32 v211, 2, v211
    v_bfe_u32 v211, v213, v211, 4
    v_mul_u32_u24 v211, 544, v211
    v_cmp_lt_u32 vcc, 11, v218
    v_lshl_add_u32 v211, v219, 3, v211
    v_add_u32 v211, s52, v211
    v_cndmask_b32 v218, 0, 8, vcc
    v_add_u32 v211, 8440, v211
    v_add_u32 v211, v218, v211
    v_cmp_eq_u32 vcc, 0, v219
    v_add_u32 v218, 512, v209
    s_nop 0
    v_cndmask_b32 v213, v211, v218, vcc
    s_mul_i32 s53, s30, 4576
    s_add_u32 s53, s53, 126976
    v_lshlrev_b32 v218, 5, v216
    v_lshl_add_u32 v214, v217, 4, v218
    v_add_u32 v214, s53, v214
    v_lshl_add_u32 v215, v217, 3, v218
    v_add_u32 v215, s53, v215
    s_setprio 0
    s_waitcnt vmcnt(0)
    s_waitcnt lgkmcnt(0)
    ds_read_b128 v[144:147], v214 offset:448
    ds_read_b64 v[80:81], v208 offset:0
    ds_read_b64 v[82:83], v209 offset:0
    ds_read_b128 v[148:151], v214 offset:960
    ds_read_b64 v[84:85], v208 offset:128
    ds_read_b64 v[86:87], v209 offset:128
    ds_read_b128 v[152:155], v214 offset:1472
    ds_read_b64 v[88:89], v208 offset:256
    ds_read_b64 v[90:91], v209 offset:256
    ds_read_b128 v[156:159], v214 offset:1984
    ds_read_b64 v[92:93], v208 offset:384
    ds_read_b64 v[94:95], v209 offset:384
    ds_read_b128 v[160:163], v214 offset:2496
    ds_read_b64 v[96:97], v212 offset:0
    ds_read_b64 v[98:99], v213 offset:0
    ds_read_b128 v[164:167], v214 offset:3008
    ds_read_b64 v[100:101], v210 offset:128
    ds_read_b64 v[102:103], v211 offset:128
    ds_read_b128 v[168:171], v214 offset:3520
    ds_read_b64 v[104:105], v210 offset:256
    ds_read_b64 v[106:107], v211 offset:256
    ds_read_b128 v[172:175], v214 offset:4032
    ds_read_b64 v[108:109], v210 offset:384
    ds_read_b64 v[110:111], v211 offset:384
    s_waitcnt lgkmcnt(0)
    v_mfma_f32_16x16x32_bf16 v[48:51], v[80:83], v[144:147], 0
    ds_read_b128 v[176:179], v214 offset:384
    v_mfma_f32_16x16x32_bf16 v[52:55], v[80:83], v[148:151], 0
    ds_read_b64 v[112:113], v208 offset:16
    v_mfma_f32_16x16x32_bf16 v[56:59], v[80:83], v[152:155], 0
    ds_read_b64 v[114:115], v209 offset:16
    v_mfma_f32_16x16x32_bf16 v[60:63], v[80:83], v[156:159], 0
    ds_read_b128 v[180:183], v214 offset:896
    v_mfma_f32_16x16x32_bf16 v[64:67], v[80:83], v[160:163], 0
    ds_read_b64 v[116:117], v208 offset:144
    v_mfma_f32_16x16x32_bf16 v[68:71], v[80:83], v[164:167], 0
    ds_read_b64 v[118:119], v209 offset:144
    v_mfma_f32_16x16x32_bf16 v[72:75], v[80:83], v[168:171], 0
    ds_read_b128 v[184:187], v214 offset:1408
    v_mfma_f32_16x16x32_bf16 v[76:79], v[80:83], v[172:175], 0
    ds_read_b64 v[120:121], v208 offset:272
    v_mfma_f32_16x16x32_bf16 v[52:55], v[84:87], v[144:147], v[52:55]
    ds_read_b64 v[122:123], v209 offset:272
    v_mfma_f32_16x16x32_bf16 v[56:59], v[84:87], v[148:151], v[56:59]
    ds_read_b128 v[188:191], v214 offset:1920
    v_mfma_f32_16x16x32_bf16 v[60:63], v[84:87], v[152:155], v[60:63]
    ds_read_b64 v[124:125], v208 offset:400
    v_mfma_f32_16x16x32_bf16 v[64:67], v[84:87], v[156:159], v[64:67]
    ds_read_b64 v[126:127], v209 offset:400
    v_mfma_f32_16x16x32_bf16 v[68:71], v[84:87], v[160:163], v[68:71]
    ds_read_b128 v[192:195], v214 offset:2432
    v_mfma_f32_16x16x32_bf16 v[72:75], v[84:87], v[164:167], v[72:75]
    ds_read_b64 v[128:129], v210 offset:16
    v_mfma_f32_16x16x32_bf16 v[76:79], v[84:87], v[168:171], v[76:79]
    ds_read_b64 v[130:131], v211 offset:16
    v_mfma_f32_16x16x32_bf16 v[56:59], v[88:91], v[144:147], v[56:59]
    ds_read_b128 v[196:199], v214 offset:2944
    v_mfma_f32_16x16x32_bf16 v[60:63], v[88:91], v[148:151], v[60:63]
    ds_read_b64 v[132:133], v210 offset:144
    v_mfma_f32_16x16x32_bf16 v[64:67], v[88:91], v[152:155], v[64:67]
    ds_read_b64 v[134:135], v211 offset:144
    v_mfma_f32_16x16x32_bf16 v[68:71], v[88:91], v[156:159], v[68:71]
    ds_read_b128 v[200:203], v214 offset:3456
    v_mfma_f32_16x16x32_bf16 v[72:75], v[88:91], v[160:163], v[72:75]
    ds_read_b64 v[136:137], v210 offset:272
    v_mfma_f32_16x16x32_bf16 v[76:79], v[88:91], v[164:167], v[76:79]
    ds_read_b64 v[138:139], v211 offset:272
    v_mfma_f32_16x16x32_bf16 v[60:63], v[92:95], v[144:147], v[60:63]
    ds_read_b128 v[204:207], v214 offset:3968
    v_mfma_f32_16x16x32_bf16 v[64:67], v[92:95], v[148:151], v[64:67]
    ds_read_b64 v[140:141], v210 offset:400
    v_mfma_f32_16x16x32_bf16 v[68:71], v[92:95], v[152:155], v[68:71]
    ds_read_b64 v[142:143], v211 offset:400
    v_mfma_f32_16x16x32_bf16 v[72:75], v[92:95], v[156:159], v[72:75]
    v_mfma_f32_16x16x32_bf16 v[76:79], v[92:95], v[160:163], v[76:79]
    v_mfma_f32_16x16x32_bf16 v[64:67], v[96:99], v[144:147], v[64:67]
    v_mfma_f32_16x16x32_bf16 v[68:71], v[96:99], v[148:151], v[68:71]
    v_mfma_f32_16x16x32_bf16 v[72:75], v[96:99], v[152:155], v[72:75]
    v_mfma_f32_16x16x32_bf16 v[76:79], v[96:99], v[156:159], v[76:79]
    v_mfma_f32_16x16x32_bf16 v[68:71], v[100:103], v[144:147], v[68:71]
    v_mfma_f32_16x16x32_bf16 v[72:75], v[100:103], v[148:151], v[72:75]
    v_mfma_f32_16x16x32_bf16 v[76:79], v[100:103], v[152:155], v[76:79]
    v_mfma_f32_16x16x32_bf16 v[72:75], v[104:107], v[144:147], v[72:75]
    v_mfma_f32_16x16x32_bf16 v[76:79], v[104:107], v[148:151], v[76:79]
    v_mfma_f32_16x16x32_bf16 v[76:79], v[108:111], v[144:147], v[76:79]
    s_waitcnt lgkmcnt(0)
    v_mfma_f32_16x16x32_bf16 v[48:51], v[112:115], v[176:179], v[48:51]
    ds_read_b128 v[144:147], v214 offset:320
    v_mfma_f32_16x16x32_bf16 v[52:55], v[112:115], v[180:183], v[52:55]
    ds_read_b64 v[80:81], v208 offset:32
    v_mfma_f32_16x16x32_bf16 v[56:59], v[112:115], v[184:187], v[56:59]
    ds_read_b64 v[82:83], v209 offset:32
    v_mfma_f32_16x16x32_bf16 v[60:63], v[112:115], v[188:191], v[60:63]
    ds_read_b128 v[148:151], v214 offset:832
    v_mfma_f32_16x16x32_bf16 v[64:67], v[112:115], v[192:195], v[64:67]
    ds_read_b64 v[84:85], v208 offset:160
    v_mfma_f32_16x16x32_bf16 v[68:71], v[112:115], v[196:199], v[68:71]
    ds_read_b64 v[86:87], v209 offset:160
    v_mfma_f32_16x16x32_bf16 v[72:75], v[112:115], v[200:203], v[72:75]
    ds_read_b128 v[152:155], v214 offset:1344
    v_mfma_f32_16x16x32_bf16 v[76:79], v[112:115], v[204:207], v[76:79]
    ds_read_b64 v[88:89], v208 offset:288
    v_mfma_f32_16x16x32_bf16 v[52:55], v[116:119], v[176:179], v[52:55]
    ds_read_b64 v[90:91], v209 offset:288
    v_mfma_f32_16x16x32_bf16 v[56:59], v[116:119], v[180:183], v[56:59]
    ds_read_b128 v[156:159], v214 offset:1856
    v_mfma_f32_16x16x32_bf16 v[60:63], v[116:119], v[184:187], v[60:63]
    ds_read_b64 v[92:93], v208 offset:416
    v_mfma_f32_16x16x32_bf16 v[64:67], v[116:119], v[188:191], v[64:67]
    ds_read_b64 v[94:95], v209 offset:416
    v_mfma_f32_16x16x32_bf16 v[68:71], v[116:119], v[192:195], v[68:71]
    ds_read_b128 v[160:163], v214 offset:2368
    v_mfma_f32_16x16x32_bf16 v[72:75], v[116:119], v[196:199], v[72:75]
    ds_read_b64 v[96:97], v210 offset:32
    v_mfma_f32_16x16x32_bf16 v[76:79], v[116:119], v[200:203], v[76:79]
    ds_read_b64 v[98:99], v211 offset:32
    v_mfma_f32_16x16x32_bf16 v[56:59], v[120:123], v[176:179], v[56:59]
    ds_read_b128 v[164:167], v214 offset:2880
    v_mfma_f32_16x16x32_bf16 v[60:63], v[120:123], v[180:183], v[60:63]
    ds_read_b64 v[100:101], v210 offset:160
    v_mfma_f32_16x16x32_bf16 v[64:67], v[120:123], v[184:187], v[64:67]
    ds_read_b64 v[102:103], v211 offset:160
    v_mfma_f32_16x16x32_bf16 v[68:71], v[120:123], v[188:191], v[68:71]
    ds_read_b128 v[168:171], v214 offset:3392
    v_mfma_f32_16x16x32_bf16 v[72:75], v[120:123], v[192:195], v[72:75]
    ds_read_b64 v[104:105], v210 offset:288
    v_mfma_f32_16x16x32_bf16 v[76:79], v[120:123], v[196:199], v[76:79]
    ds_read_b64 v[106:107], v211 offset:288
    v_mfma_f32_16x16x32_bf16 v[60:63], v[124:127], v[176:179], v[60:63]
    ds_read_b128 v[172:175], v214 offset:3904
    v_mfma_f32_16x16x32_bf16 v[64:67], v[124:127], v[180:183], v[64:67]
    ds_read_b64 v[108:109], v210 offset:416
    v_mfma_f32_16x16x32_bf16 v[68:71], v[124:127], v[184:187], v[68:71]
    ds_read_b64 v[110:111], v211 offset:416
    v_mfma_f32_16x16x32_bf16 v[72:75], v[124:127], v[188:191], v[72:75]
    v_mfma_f32_16x16x32_bf16 v[76:79], v[124:127], v[192:195], v[76:79]
    v_mfma_f32_16x16x32_bf16 v[64:67], v[128:131], v[176:179], v[64:67]
    v_mfma_f32_16x16x32_bf16 v[68:71], v[128:131], v[180:183], v[68:71]
    v_mfma_f32_16x16x32_bf16 v[72:75], v[128:131], v[184:187], v[72:75]
    v_mfma_f32_16x16x32_bf16 v[76:79], v[128:131], v[188:191], v[76:79]
    v_mfma_f32_16x16x32_bf16 v[68:71], v[132:135], v[176:179], v[68:71]
    v_mfma_f32_16x16x32_bf16 v[72:75], v[132:135], v[180:183], v[72:75]
    v_mfma_f32_16x16x32_bf16 v[76:79], v[132:135], v[184:187], v[76:79]
    v_mfma_f32_16x16x32_bf16 v[72:75], v[136:139], v[176:179], v[72:75]
    v_mfma_f32_16x16x32_bf16 v[76:79], v[136:139], v[180:183], v[76:79]
    v_mfma_f32_16x16x32_bf16 v[76:79], v[140:143], v[176:179], v[76:79]
    s_waitcnt lgkmcnt(0)
    v_mfma_f32_16x16x32_bf16 v[48:51], v[80:83], v[144:147], v[48:51]
    ds_read_b128 v[176:179], v214 offset:256
    v_mfma_f32_16x16x32_bf16 v[52:55], v[80:83], v[148:151], v[52:55]
    ds_read_b64 v[112:113], v208 offset:48
    v_mfma_f32_16x16x32_bf16 v[56:59], v[80:83], v[152:155], v[56:59]
    ds_read_b64 v[114:115], v209 offset:48
    v_mfma_f32_16x16x32_bf16 v[60:63], v[80:83], v[156:159], v[60:63]
    ds_read_b128 v[180:183], v214 offset:768
    v_mfma_f32_16x16x32_bf16 v[64:67], v[80:83], v[160:163], v[64:67]
    ds_read_b64 v[116:117], v208 offset:176
    v_mfma_f32_16x16x32_bf16 v[68:71], v[80:83], v[164:167], v[68:71]
    ds_read_b64 v[118:119], v209 offset:176
    v_mfma_f32_16x16x32_bf16 v[72:75], v[80:83], v[168:171], v[72:75]
    ds_read_b128 v[184:187], v214 offset:1280
    v_mfma_f32_16x16x32_bf16 v[76:79], v[80:83], v[172:175], v[76:79]
    ds_read_b64 v[120:121], v208 offset:304
    v_mfma_f32_16x16x32_bf16 v[52:55], v[84:87], v[144:147], v[52:55]
    ds_read_b64 v[122:123], v209 offset:304
    v_mfma_f32_16x16x32_bf16 v[56:59], v[84:87], v[148:151], v[56:59]
    ds_read_b128 v[188:191], v214 offset:1792
    v_mfma_f32_16x16x32_bf16 v[60:63], v[84:87], v[152:155], v[60:63]
    ds_read_b64 v[124:125], v208 offset:432
    v_mfma_f32_16x16x32_bf16 v[64:67], v[84:87], v[156:159], v[64:67]
    ds_read_b64 v[126:127], v209 offset:432
    v_mfma_f32_16x16x32_bf16 v[68:71], v[84:87], v[160:163], v[68:71]
    ds_read_b128 v[192:195], v214 offset:2304
    v_mfma_f32_16x16x32_bf16 v[72:75], v[84:87], v[164:167], v[72:75]
    ds_read_b64 v[128:129], v210 offset:48
    v_mfma_f32_16x16x32_bf16 v[76:79], v[84:87], v[168:171], v[76:79]
    ds_read_b64 v[130:131], v211 offset:48
    v_mfma_f32_16x16x32_bf16 v[56:59], v[88:91], v[144:147], v[56:59]
    ds_read_b128 v[196:199], v214 offset:2816
    v_mfma_f32_16x16x32_bf16 v[60:63], v[88:91], v[148:151], v[60:63]
    ds_read_b64 v[132:133], v210 offset:176
    v_mfma_f32_16x16x32_bf16 v[64:67], v[88:91], v[152:155], v[64:67]
    ds_read_b64 v[134:135], v211 offset:176
    v_mfma_f32_16x16x32_bf16 v[68:71], v[88:91], v[156:159], v[68:71]
    ds_read_b128 v[200:203], v214 offset:3328
    v_mfma_f32_16x16x32_bf16 v[72:75], v[88:91], v[160:163], v[72:75]
    ds_read_b64 v[136:137], v210 offset:304
    v_mfma_f32_16x16x32_bf16 v[76:79], v[88:91], v[164:167], v[76:79]
    ds_read_b64 v[138:139], v211 offset:304
    v_mfma_f32_16x16x32_bf16 v[60:63], v[92:95], v[144:147], v[60:63]
    ds_read_b128 v[204:207], v214 offset:3840
    v_mfma_f32_16x16x32_bf16 v[64:67], v[92:95], v[148:151], v[64:67]
    ds_read_b64 v[140:141], v210 offset:432
    v_mfma_f32_16x16x32_bf16 v[68:71], v[92:95], v[152:155], v[68:71]
    ds_read_b64 v[142:143], v211 offset:432
    v_mfma_f32_16x16x32_bf16 v[72:75], v[92:95], v[156:159], v[72:75]
    v_mfma_f32_16x16x32_bf16 v[76:79], v[92:95], v[160:163], v[76:79]
    v_mfma_f32_16x16x32_bf16 v[64:67], v[96:99], v[144:147], v[64:67]
    v_mfma_f32_16x16x32_bf16 v[68:71], v[96:99], v[148:151], v[68:71]
    v_mfma_f32_16x16x32_bf16 v[72:75], v[96:99], v[152:155], v[72:75]
    v_mfma_f32_16x16x32_bf16 v[76:79], v[96:99], v[156:159], v[76:79]
    v_mfma_f32_16x16x32_bf16 v[68:71], v[100:103], v[144:147], v[68:71]
    v_mfma_f32_16x16x32_bf16 v[72:75], v[100:103], v[148:151], v[72:75]
    v_mfma_f32_16x16x32_bf16 v[76:79], v[100:103], v[152:155], v[76:79]
    v_mfma_f32_16x16x32_bf16 v[72:75], v[104:107], v[144:147], v[72:75]
    v_mfma_f32_16x16x32_bf16 v[76:79], v[104:107], v[148:151], v[76:79]
    v_mfma_f32_16x16x32_bf16 v[76:79], v[108:111], v[144:147], v[76:79]
    s_waitcnt lgkmcnt(0)
    v_mfma_f32_16x16x32_bf16 v[48:51], v[112:115], v[176:179], v[48:51]
    ds_read_b128 v[144:147], v214 offset:192
    v_mfma_f32_16x16x32_bf16 v[52:55], v[112:115], v[180:183], v[52:55]
    ds_read_b64 v[80:81], v208 offset:64
    v_mfma_f32_16x16x32_bf16 v[56:59], v[112:115], v[184:187], v[56:59]
    ds_read_b64 v[82:83], v209 offset:64
    v_mfma_f32_16x16x32_bf16 v[60:63], v[112:115], v[188:191], v[60:63]
    ds_read_b128 v[148:151], v214 offset:704
    v_mfma_f32_16x16x32_bf16 v[64:67], v[112:115], v[192:195], v[64:67]
    ds_read_b64 v[84:85], v208 offset:192
    v_mfma_f32_16x16x32_bf16 v[68:71], v[112:115], v[196:199], v[68:71]
    ds_read_b64 v[86:87], v209 offset:192
    v_mfma_f32_16x16x32_bf16 v[72:75], v[112:115], v[200:203], v[72:75]
    ds_read_b128 v[152:155], v214 offset:1216
    v_mfma_f32_16x16x32_bf16 v[76:79], v[112:115], v[204:207], v[76:79]
    ds_read_b64 v[88:89], v208 offset:320
    v_mfma_f32_16x16x32_bf16 v[52:55], v[116:119], v[176:179], v[52:55]
    ds_read_b64 v[90:91], v209 offset:320
    v_mfma_f32_16x16x32_bf16 v[56:59], v[116:119], v[180:183], v[56:59]
    ds_read_b128 v[156:159], v214 offset:1728
    v_mfma_f32_16x16x32_bf16 v[60:63], v[116:119], v[184:187], v[60:63]
    ds_read_b64 v[92:93], v208 offset:448
    v_mfma_f32_16x16x32_bf16 v[64:67], v[116:119], v[188:191], v[64:67]
    ds_read_b64 v[94:95], v209 offset:448
    v_mfma_f32_16x16x32_bf16 v[68:71], v[116:119], v[192:195], v[68:71]
    ds_read_b128 v[160:163], v214 offset:2240
    v_mfma_f32_16x16x32_bf16 v[72:75], v[116:119], v[196:199], v[72:75]
    ds_read_b64 v[96:97], v210 offset:64
    v_mfma_f32_16x16x32_bf16 v[76:79], v[116:119], v[200:203], v[76:79]
    ds_read_b64 v[98:99], v211 offset:64
    v_mfma_f32_16x16x32_bf16 v[56:59], v[120:123], v[176:179], v[56:59]
    ds_read_b128 v[164:167], v214 offset:2752
    v_mfma_f32_16x16x32_bf16 v[60:63], v[120:123], v[180:183], v[60:63]
    ds_read_b64 v[100:101], v210 offset:192
    v_mfma_f32_16x16x32_bf16 v[64:67], v[120:123], v[184:187], v[64:67]
    ds_read_b64 v[102:103], v211 offset:192
    v_mfma_f32_16x16x32_bf16 v[68:71], v[120:123], v[188:191], v[68:71]
    ds_read_b128 v[168:171], v214 offset:3264
    v_mfma_f32_16x16x32_bf16 v[72:75], v[120:123], v[192:195], v[72:75]
    ds_read_b64 v[104:105], v210 offset:320
    v_mfma_f32_16x16x32_bf16 v[76:79], v[120:123], v[196:199], v[76:79]
    ds_read_b64 v[106:107], v211 offset:320
    v_mfma_f32_16x16x32_bf16 v[60:63], v[124:127], v[176:179], v[60:63]
    ds_read_b128 v[172:175], v214 offset:3776
    v_mfma_f32_16x16x32_bf16 v[64:67], v[124:127], v[180:183], v[64:67]
    ds_read_b64 v[108:109], v210 offset:448
    v_mfma_f32_16x16x32_bf16 v[68:71], v[124:127], v[184:187], v[68:71]
    ds_read_b64 v[110:111], v211 offset:448
    v_mfma_f32_16x16x32_bf16 v[72:75], v[124:127], v[188:191], v[72:75]
    v_mfma_f32_16x16x32_bf16 v[76:79], v[124:127], v[192:195], v[76:79]
    v_mfma_f32_16x16x32_bf16 v[64:67], v[128:131], v[176:179], v[64:67]
    v_mfma_f32_16x16x32_bf16 v[68:71], v[128:131], v[180:183], v[68:71]
    v_mfma_f32_16x16x32_bf16 v[72:75], v[128:131], v[184:187], v[72:75]
    v_mfma_f32_16x16x32_bf16 v[76:79], v[128:131], v[188:191], v[76:79]
    v_mfma_f32_16x16x32_bf16 v[68:71], v[132:135], v[176:179], v[68:71]
    v_mfma_f32_16x16x32_bf16 v[72:75], v[132:135], v[180:183], v[72:75]
    v_mfma_f32_16x16x32_bf16 v[76:79], v[132:135], v[184:187], v[76:79]
    v_mfma_f32_16x16x32_bf16 v[72:75], v[136:139], v[176:179], v[72:75]
    v_mfma_f32_16x16x32_bf16 v[76:79], v[136:139], v[180:183], v[76:79]
    v_mfma_f32_16x16x32_bf16 v[76:79], v[140:143], v[176:179], v[76:79]
    s_waitcnt lgkmcnt(0)
    v_mfma_f32_16x16x32_bf16 v[48:51], v[80:83], v[144:147], v[48:51]
    ds_read_b128 v[176:179], v214 offset:128
    v_mfma_f32_16x16x32_bf16 v[52:55], v[80:83], v[148:151], v[52:55]
    ds_read_b64 v[112:113], v208 offset:80
    v_mfma_f32_16x16x32_bf16 v[56:59], v[80:83], v[152:155], v[56:59]
    ds_read_b64 v[114:115], v209 offset:80
    v_mfma_f32_16x16x32_bf16 v[60:63], v[80:83], v[156:159], v[60:63]
    ds_read_b128 v[180:183], v214 offset:640
    v_mfma_f32_16x16x32_bf16 v[64:67], v[80:83], v[160:163], v[64:67]
    ds_read_b64 v[116:117], v208 offset:208
    v_mfma_f32_16x16x32_bf16 v[68:71], v[80:83], v[164:167], v[68:71]
    ds_read_b64 v[118:119], v209 offset:208
    v_mfma_f32_16x16x32_bf16 v[72:75], v[80:83], v[168:171], v[72:75]
    ds_read_b128 v[184:187], v214 offset:1152
    v_mfma_f32_16x16x32_bf16 v[76:79], v[80:83], v[172:175], v[76:79]
    ds_read_b64 v[120:121], v208 offset:336
    v_mfma_f32_16x16x32_bf16 v[52:55], v[84:87], v[144:147], v[52:55]
    ds_read_b64 v[122:123], v209 offset:336
    v_mfma_f32_16x16x32_bf16 v[56:59], v[84:87], v[148:151], v[56:59]
    ds_read_b128 v[188:191], v214 offset:1664
    v_mfma_f32_16x16x32_bf16 v[60:63], v[84:87], v[152:155], v[60:63]
    ds_read_b64 v[124:125], v208 offset:464
    v_mfma_f32_16x16x32_bf16 v[64:67], v[84:87], v[156:159], v[64:67]
    ds_read_b64 v[126:127], v209 offset:464
    v_mfma_f32_16x16x32_bf16 v[68:71], v[84:87], v[160:163], v[68:71]
    ds_read_b128 v[192:195], v214 offset:2176
    v_mfma_f32_16x16x32_bf16 v[72:75], v[84:87], v[164:167], v[72:75]
    ds_read_b64 v[128:129], v210 offset:80
    v_mfma_f32_16x16x32_bf16 v[76:79], v[84:87], v[168:171], v[76:79]
    ds_read_b64 v[130:131], v211 offset:80
    v_mfma_f32_16x16x32_bf16 v[56:59], v[88:91], v[144:147], v[56:59]
    ds_read_b128 v[196:199], v214 offset:2688
    v_mfma_f32_16x16x32_bf16 v[60:63], v[88:91], v[148:151], v[60:63]
    ds_read_b64 v[132:133], v210 offset:208
    v_mfma_f32_16x16x32_bf16 v[64:67], v[88:91], v[152:155], v[64:67]
    ds_read_b64 v[134:135], v211 offset:208
    v_mfma_f32_16x16x32_bf16 v[68:71], v[88:91], v[156:159], v[68:71]
    ds_read_b128 v[200:203], v214 offset:3200
    v_mfma_f32_16x16x32_bf16 v[72:75], v[88:91], v[160:163], v[72:75]
    ds_read_b64 v[136:137], v210 offset:336
    v_mfma_f32_16x16x32_bf16 v[76:79], v[88:91], v[164:167], v[76:79]
    ds_read_b64 v[138:139], v211 offset:336
    v_mfma_f32_16x16x32_bf16 v[60:63], v[92:95], v[144:147], v[60:63]
    ds_read_b128 v[204:207], v214 offset:3712
    v_mfma_f32_16x16x32_bf16 v[64:67], v[92:95], v[148:151], v[64:67]
    ds_read_b64 v[140:141], v210 offset:464
    v_mfma_f32_16x16x32_bf16 v[68:71], v[92:95], v[152:155], v[68:71]
    ds_read_b64 v[142:143], v211 offset:464
    v_mfma_f32_16x16x32_bf16 v[72:75], v[92:95], v[156:159], v[72:75]
    v_mfma_f32_16x16x32_bf16 v[76:79], v[92:95], v[160:163], v[76:79]
    v_mfma_f32_16x16x32_bf16 v[64:67], v[96:99], v[144:147], v[64:67]
    v_mfma_f32_16x16x32_bf16 v[68:71], v[96:99], v[148:151], v[68:71]
    v_mfma_f32_16x16x32_bf16 v[72:75], v[96:99], v[152:155], v[72:75]
    v_mfma_f32_16x16x32_bf16 v[76:79], v[96:99], v[156:159], v[76:79]
    v_mfma_f32_16x16x32_bf16 v[68:71], v[100:103], v[144:147], v[68:71]
    v_mfma_f32_16x16x32_bf16 v[72:75], v[100:103], v[148:151], v[72:75]
    v_mfma_f32_16x16x32_bf16 v[76:79], v[100:103], v[152:155], v[76:79]
    v_mfma_f32_16x16x32_bf16 v[72:75], v[104:107], v[144:147], v[72:75]
    v_mfma_f32_16x16x32_bf16 v[76:79], v[104:107], v[148:151], v[76:79]
    v_mfma_f32_16x16x32_bf16 v[76:79], v[108:111], v[144:147], v[76:79]
    s_waitcnt lgkmcnt(0)
    v_mfma_f32_16x16x32_bf16 v[48:51], v[112:115], v[176:179], v[48:51]
    ds_read_b128 v[144:147], v214 offset:64
    v_mfma_f32_16x16x32_bf16 v[52:55], v[112:115], v[180:183], v[52:55]
    ds_read_b64 v[80:81], v208 offset:96
    v_mfma_f32_16x16x32_bf16 v[56:59], v[112:115], v[184:187], v[56:59]
    ds_read_b64 v[82:83], v209 offset:96
    v_mfma_f32_16x16x32_bf16 v[60:63], v[112:115], v[188:191], v[60:63]
    ds_read_b128 v[148:151], v214 offset:576
    v_mfma_f32_16x16x32_bf16 v[64:67], v[112:115], v[192:195], v[64:67]
    ds_read_b64 v[84:85], v208 offset:224
    v_mfma_f32_16x16x32_bf16 v[68:71], v[112:115], v[196:199], v[68:71]
    ds_read_b64 v[86:87], v209 offset:224
    v_mfma_f32_16x16x32_bf16 v[72:75], v[112:115], v[200:203], v[72:75]
    ds_read_b128 v[152:155], v214 offset:1088
    v_mfma_f32_16x16x32_bf16 v[76:79], v[112:115], v[204:207], v[76:79]
    ds_read_b64 v[88:89], v208 offset:352
    v_mfma_f32_16x16x32_bf16 v[52:55], v[116:119], v[176:179], v[52:55]
    ds_read_b64 v[90:91], v209 offset:352
    v_mfma_f32_16x16x32_bf16 v[56:59], v[116:119], v[180:183], v[56:59]
    ds_read_b128 v[156:159], v214 offset:1600
    v_mfma_f32_16x16x32_bf16 v[60:63], v[116:119], v[184:187], v[60:63]
    ds_read_b64 v[92:93], v208 offset:480
    v_mfma_f32_16x16x32_bf16 v[64:67], v[116:119], v[188:191], v[64:67]
    ds_read_b64 v[94:95], v209 offset:480
    v_mfma_f32_16x16x32_bf16 v[68:71], v[116:119], v[192:195], v[68:71]
    ds_read_b128 v[160:163], v214 offset:2112
    v_mfma_f32_16x16x32_bf16 v[72:75], v[116:119], v[196:199], v[72:75]
    ds_read_b64 v[96:97], v210 offset:96
    v_mfma_f32_16x16x32_bf16 v[76:79], v[116:119], v[200:203], v[76:79]
    ds_read_b64 v[98:99], v211 offset:96
    v_mfma_f32_16x16x32_bf16 v[56:59], v[120:123], v[176:179], v[56:59]
    ds_read_b128 v[164:167], v214 offset:2624
    v_mfma_f32_16x16x32_bf16 v[60:63], v[120:123], v[180:183], v[60:63]
    ds_read_b64 v[100:101], v210 offset:224
    v_mfma_f32_16x16x32_bf16 v[64:67], v[120:123], v[184:187], v[64:67]
    ds_read_b64 v[102:103], v211 offset:224
    v_mfma_f32_16x16x32_bf16 v[68:71], v[120:123], v[188:191], v[68:71]
    ds_read_b128 v[168:171], v214 offset:3136
    v_mfma_f32_16x16x32_bf16 v[72:75], v[120:123], v[192:195], v[72:75]
    ds_read_b64 v[104:105], v210 offset:352
    v_mfma_f32_16x16x32_bf16 v[76:79], v[120:123], v[196:199], v[76:79]
    ds_read_b64 v[106:107], v211 offset:352
    v_mfma_f32_16x16x32_bf16 v[60:63], v[124:127], v[176:179], v[60:63]
    ds_read_b128 v[172:175], v214 offset:3648
    v_mfma_f32_16x16x32_bf16 v[64:67], v[124:127], v[180:183], v[64:67]
    ds_read_b64 v[108:109], v210 offset:480
    v_mfma_f32_16x16x32_bf16 v[68:71], v[124:127], v[184:187], v[68:71]
    ds_read_b64 v[110:111], v211 offset:480
    v_mfma_f32_16x16x32_bf16 v[72:75], v[124:127], v[188:191], v[72:75]
    v_mfma_f32_16x16x32_bf16 v[76:79], v[124:127], v[192:195], v[76:79]
    v_mfma_f32_16x16x32_bf16 v[64:67], v[128:131], v[176:179], v[64:67]
    v_mfma_f32_16x16x32_bf16 v[68:71], v[128:131], v[180:183], v[68:71]
    v_mfma_f32_16x16x32_bf16 v[72:75], v[128:131], v[184:187], v[72:75]
    v_mfma_f32_16x16x32_bf16 v[76:79], v[128:131], v[188:191], v[76:79]
    v_mfma_f32_16x16x32_bf16 v[68:71], v[132:135], v[176:179], v[68:71]
    v_mfma_f32_16x16x32_bf16 v[72:75], v[132:135], v[180:183], v[72:75]
    v_mfma_f32_16x16x32_bf16 v[76:79], v[132:135], v[184:187], v[76:79]
    v_mfma_f32_16x16x32_bf16 v[72:75], v[136:139], v[176:179], v[72:75]
    v_mfma_f32_16x16x32_bf16 v[76:79], v[136:139], v[180:183], v[76:79]
    v_mfma_f32_16x16x32_bf16 v[76:79], v[140:143], v[176:179], v[76:79]
    s_waitcnt lgkmcnt(0)
    v_mfma_f32_16x16x32_bf16 v[48:51], v[80:83], v[144:147], v[48:51]
    ds_read_b128 v[176:179], v214 offset:0
    v_mfma_f32_16x16x32_bf16 v[52:55], v[80:83], v[148:151], v[52:55]
    ds_read_b64 v[112:113], v208 offset:112
    v_mfma_f32_16x16x32_bf16 v[56:59], v[80:83], v[152:155], v[56:59]
    ds_read_b64 v[114:115], v209 offset:112
    v_mfma_f32_16x16x32_bf16 v[60:63], v[80:83], v[156:159], v[60:63]
    ds_read_b128 v[180:183], v214 offset:512
    v_mfma_f32_16x16x32_bf16 v[64:67], v[80:83], v[160:163], v[64:67]
    ds_read_b64 v[116:117], v208 offset:240
    v_mfma_f32_16x16x32_bf16 v[68:71], v[80:83], v[164:167], v[68:71]
    ds_read_b64 v[118:119], v209 offset:240
    v_mfma_f32_16x16x32_bf16 v[72:75], v[80:83], v[168:171], v[72:75]
    ds_read_b128 v[184:187], v214 offset:1024
    v_mfma_f32_16x16x32_bf16 v[76:79], v[80:83], v[172:175], v[76:79]
    ds_read_b64 v[120:121], v208 offset:368
    v_mfma_f32_16x16x32_bf16 v[52:55], v[84:87], v[144:147], v[52:55]
    ds_read_b64 v[122:123], v209 offset:368
    v_mfma_f32_16x16x32_bf16 v[56:59], v[84:87], v[148:151], v[56:59]
    ds_read_b128 v[188:191], v214 offset:1536
    v_mfma_f32_16x16x32_bf16 v[60:63], v[84:87], v[152:155], v[60:63]
    ds_read_b64 v[124:125], v208 offset:496
    v_mfma_f32_16x16x32_bf16 v[64:67], v[84:87], v[156:159], v[64:67]
    ds_read_b64 v[126:127], v209 offset:496
    v_mfma_f32_16x16x32_bf16 v[68:71], v[84:87], v[160:163], v[68:71]
    ds_read_b128 v[192:195], v214 offset:2048
    v_mfma_f32_16x16x32_bf16 v[72:75], v[84:87], v[164:167], v[72:75]
    ds_read_b64 v[128:129], v210 offset:112
    v_mfma_f32_16x16x32_bf16 v[76:79], v[84:87], v[168:171], v[76:79]
    ds_read_b64 v[130:131], v211 offset:112
    v_mfma_f32_16x16x32_bf16 v[56:59], v[88:91], v[144:147], v[56:59]
    ds_read_b128 v[196:199], v214 offset:2560
    v_mfma_f32_16x16x32_bf16 v[60:63], v[88:91], v[148:151], v[60:63]
    ds_read_b64 v[132:133], v210 offset:240
    v_mfma_f32_16x16x32_bf16 v[64:67], v[88:91], v[152:155], v[64:67]
    ds_read_b64 v[134:135], v211 offset:240
    v_mfma_f32_16x16x32_bf16 v[68:71], v[88:91], v[156:159], v[68:71]
    ds_read_b128 v[200:203], v214 offset:3072
    v_mfma_f32_16x16x32_bf16 v[72:75], v[88:91], v[160:163], v[72:75]
    ds_read_b64 v[136:137], v210 offset:368
    v_mfma_f32_16x16x32_bf16 v[76:79], v[88:91], v[164:167], v[76:79]
    ds_read_b64 v[138:139], v211 offset:368
    v_mfma_f32_16x16x32_bf16 v[60:63], v[92:95], v[144:147], v[60:63]
    ds_read_b128 v[204:207], v214 offset:3584
    v_mfma_f32_16x16x32_bf16 v[64:67], v[92:95], v[148:151], v[64:67]
    ds_read_b64 v[140:141], v210 offset:496
    v_mfma_f32_16x16x32_bf16 v[68:71], v[92:95], v[152:155], v[68:71]
    ds_read_b64 v[142:143], v211 offset:496
    v_mfma_f32_16x16x32_bf16 v[72:75], v[92:95], v[156:159], v[72:75]
    v_mfma_f32_16x16x32_bf16 v[76:79], v[92:95], v[160:163], v[76:79]
    v_mfma_f32_16x16x32_bf16 v[64:67], v[96:99], v[144:147], v[64:67]
    v_mfma_f32_16x16x32_bf16 v[68:71], v[96:99], v[148:151], v[68:71]
    v_mfma_f32_16x16x32_bf16 v[72:75], v[96:99], v[152:155], v[72:75]
    v_mfma_f32_16x16x32_bf16 v[76:79], v[96:99], v[156:159], v[76:79]
    v_mfma_f32_16x16x32_bf16 v[68:71], v[100:103], v[144:147], v[68:71]
    v_mfma_f32_16x16x32_bf16 v[72:75], v[100:103], v[148:151], v[72:75]
    v_mfma_f32_16x16x32_bf16 v[76:79], v[100:103], v[152:155], v[76:79]
    v_mfma_f32_16x16x32_bf16 v[72:75], v[104:107], v[144:147], v[72:75]
    v_mfma_f32_16x16x32_bf16 v[76:79], v[104:107], v[148:151], v[76:79]
    v_mfma_f32_16x16x32_bf16 v[76:79], v[108:111], v[144:147], v[76:79]
    s_waitcnt lgkmcnt(0)
    v_mfma_f32_16x16x32_bf16 v[48:51], v[112:115], v[176:179], v[48:51]
    v_mfma_f32_16x16x32_bf16 v[52:55], v[112:115], v[180:183], v[52:55]
    v_mfma_f32_16x16x32_bf16 v[56:59], v[112:115], v[184:187], v[56:59]
    v_mfma_f32_16x16x32_bf16 v[60:63], v[112:115], v[188:191], v[60:63]
    v_mfma_f32_16x16x32_bf16 v[64:67], v[112:115], v[192:195], v[64:67]
    v_mfma_f32_16x16x32_bf16 v[68:71], v[112:115], v[196:199], v[68:71]
    v_mfma_f32_16x16x32_bf16 v[72:75], v[112:115], v[200:203], v[72:75]
    v_mfma_f32_16x16x32_bf16 v[76:79], v[112:115], v[204:207], v[76:79]
    v_mfma_f32_16x16x32_bf16 v[52:55], v[116:119], v[176:179], v[52:55]
    v_mfma_f32_16x16x32_bf16 v[56:59], v[116:119], v[180:183], v[56:59]
    v_mfma_f32_16x16x32_bf16 v[60:63], v[116:119], v[184:187], v[60:63]
    v_mfma_f32_16x16x32_bf16 v[64:67], v[116:119], v[188:191], v[64:67]
    v_mfma_f32_16x16x32_bf16 v[68:71], v[116:119], v[192:195], v[68:71]
    v_mfma_f32_16x16x32_bf16 v[72:75], v[116:119], v[196:199], v[72:75]
    v_mfma_f32_16x16x32_bf16 v[76:79], v[116:119], v[200:203], v[76:79]
    v_mfma_f32_16x16x32_bf16 v[56:59], v[120:123], v[176:179], v[56:59]
    v_mfma_f32_16x16x32_bf16 v[60:63], v[120:123], v[180:183], v[60:63]
    v_mfma_f32_16x16x32_bf16 v[64:67], v[120:123], v[184:187], v[64:67]
    v_mfma_f32_16x16x32_bf16 v[68:71], v[120:123], v[188:191], v[68:71]
    v_mfma_f32_16x16x32_bf16 v[72:75], v[120:123], v[192:195], v[72:75]
    v_mfma_f32_16x16x32_bf16 v[76:79], v[120:123], v[196:199], v[76:79]
    v_mfma_f32_16x16x32_bf16 v[60:63], v[124:127], v[176:179], v[60:63]
    v_mfma_f32_16x16x32_bf16 v[64:67], v[124:127], v[180:183], v[64:67]
    v_mfma_f32_16x16x32_bf16 v[68:71], v[124:127], v[184:187], v[68:71]
    v_mfma_f32_16x16x32_bf16 v[72:75], v[124:127], v[188:191], v[72:75]
    v_mfma_f32_16x16x32_bf16 v[76:79], v[124:127], v[192:195], v[76:79]
    v_mfma_f32_16x16x32_bf16 v[64:67], v[128:131], v[176:179], v[64:67]
    v_mfma_f32_16x16x32_bf16 v[68:71], v[128:131], v[180:183], v[68:71]
    v_mfma_f32_16x16x32_bf16 v[72:75], v[128:131], v[184:187], v[72:75]
    v_mfma_f32_16x16x32_bf16 v[76:79], v[128:131], v[188:191], v[76:79]
    v_mfma_f32_16x16x32_bf16 v[68:71], v[132:135], v[176:179], v[68:71]
    v_mfma_f32_16x16x32_bf16 v[72:75], v[132:135], v[180:183], v[72:75]
    v_mfma_f32_16x16x32_bf16 v[76:79], v[132:135], v[184:187], v[76:79]
    v_mfma_f32_16x16x32_bf16 v[72:75], v[136:139], v[176:179], v[72:75]
    v_mfma_f32_16x16x32_bf16 v[76:79], v[136:139], v[180:183], v[76:79]
    v_mfma_f32_16x16x32_bf16 v[76:79], v[140:143], v[176:179], v[76:79]
    s_nop 7
    v_cvt_pk_bf16_f32 v144, v48, v49
    v_cvt_pk_bf16_f32 v145, v50, v51
    ds_write_b64 v215, v[144:145] offset:480
    v_cvt_pk_bf16_f32 v148, v52, v53
    v_cvt_pk_bf16_f32 v149, v54, v55
    ds_write_b64 v215, v[148:149] offset:992
    v_cvt_pk_bf16_f32 v152, v56, v57
    v_cvt_pk_bf16_f32 v153, v58, v59
    ds_write_b64 v215, v[152:153] offset:1504
    v_cvt_pk_bf16_f32 v156, v60, v61
    v_cvt_pk_bf16_f32 v157, v62, v63
    ds_write_b64 v215, v[156:157] offset:2016
    v_cvt_pk_bf16_f32 v160, v64, v65
    v_cvt_pk_bf16_f32 v161, v66, v67
    ds_write_b64 v215, v[160:161] offset:2528
    v_cvt_pk_bf16_f32 v164, v68, v69
    v_cvt_pk_bf16_f32 v165, v70, v71
    ds_write_b64 v215, v[164:165] offset:3040
    v_cvt_pk_bf16_f32 v168, v72, v73
    v_cvt_pk_bf16_f32 v169, v74, v75
    s_nop 4
    ds_write_b64 v215, v[168:169] offset:3552
    v_cvt_pk_bf16_f32 v172, v76, v77
    v_cvt_pk_bf16_f32 v173, v78, v79
    ds_write_b64 v215, v[172:173] offset:4064
    s_mul_i32 s53, s30, 4576
    s_add_u32 s53, s53, 127456
    v_lshlrev_b32 v218, 4, v0
    v_add_u32 v219, s53, v218
    s_lshl_b32 s52, s60, 12
    s_add_u32 s52, s52, 0x710000
    s_waitcnt lgkmcnt(0)
    ds_read_b128 v[192:195], v219 offset:0
    ds_read_b128 v[196:199], v219 offset:1024
    ds_read_b128 v[200:203], v219 offset:2048
    ds_read_b128 v[204:207], v219 offset:3072
    s_waitcnt lgkmcnt(3)
    buffer_store_dwordx4 v[192:195], v218, s[40:43], s52 offen offset:0 sc1
    s_waitcnt lgkmcnt(2)
    buffer_store_dwordx4 v[196:199], v218, s[40:43], s52 offen offset:1024 sc1
    s_waitcnt lgkmcnt(1)
    buffer_store_dwordx4 v[200:203], v218, s[40:43], s52 offen offset:2048 sc1
    s_waitcnt lgkmcnt(0)
    buffer_store_dwordx4 v[204:207], v218, s[40:43], s52 offen offset:3072 sc1
    s_lshl_b32 s52, s66, 7
    s_lshl_b32 s53, s30, 2
    s_add_u32 s52, s52, s53
    s_add_u32 s52, s52, 0xe10000
    s_waitcnt vmcnt(0)
    v_mov_b32 v1, s67
    v_mov_b32 v2, 0
    s_mov_b64 exec, 1
    buffer_store_dword v1, v2, s[40:43], s52 offen sc1
    s_mov_b64 exec, -1
    s_endpgm
role_g:
    s_sub_u32 s52, s2, 80
    s_lshr_b32 s64, s52, 3
    s_and_b32 s53, s52, 1
    s_bfe_u32 s54, s52, 0x20001
    s_lshl_b32 s54, s54, 2
    s_lshr_b32 s55, s64, 2
    s_mul_i32 s61, s53, 6
    s_add_u32 s61, s61, s55
    s_mul_i32 s63, s53, 5
    s_add_u32 s63, s63, s55
    s_and_b32 s60, s64, 3
    s_lshl_b32 s53, s53, 1
    s_add_u32 s53, s53, s60
    s_cmp_ge_u32 s64, 20
    s_cselect_b32 s61, 5, s61
    s_cselect_b32 s60, s53, s60
    s_mul_i32 s56, s60, 5
    s_lshr_b32 s56, s56, 1
    s_and_b32 s57, s64, 1
    s_mul_i32 s57, s57, 5
    s_add_u32 s57, s57, 1
    s_lshl_b32 s55, s55, 1
    s_add_u32 s56, s56, s55
    s_cmp_ge_u32 s64, 20
    s_cselect_b32 s56, s57, s56
    s_lshr_b32 s57, s54, 2
    s_mul_i32 s57, s57, 0
    s_add_u32 s56, s56, s57
    s_and_b32 s57, s2, 1
    s_mul_i32 s57, s57, 1
    s_add_u32 s56, s56, s57
    s_sub_u32 s55, s56, 10
    s_cselect_b32 s62, s56, s55
    s_sub_u32 s55, s62, 10
    s_cselect_b32 s62, s62, s55
    s_sub_u32 s55, s56, 9
    s_cselect_b32 s65, s56, s55
    s_sub_u32 s55, s65, 9
    s_cselect_b32 s65, s65, s55
    s_add_u32 s60, s60, s54
    s_and_b32 s53, s2, 1
    s_lshl_b32 s53, s53, 1
    s_and_b32 s55, s64, 1
    s_add_u32 s66, s54, s53
    s_add_u32 s66, s66, s55
    s_lshr_b32 s63, s64, 1
    s_mul_i32 s55, s55, 2
    s_add_u32 s65, s63, s55
    s_and_b32 s55, s2, 7
    s_mul_i32 s55, s55, 4
    s_add_u32 s65, s65, s55
    s_sub_u32 s55, s65, 9
    s_cselect_b32 s65, s65, s55
    s_sub_u32 s55, s65, 9
    s_cselect_b32 s65, s65, s55
    s_sub_u32 s55, s65, 9
    s_cselect_b32 s65, s65, s55
    s_sub_u32 s55, s65, 9
    s_cselect_b32 s65, s65, s55
    s_waitcnt lgkmcnt(0)
    s_mov_b32 s32, s4
    s_and_b32 s33, s5, 0xffff
    s_mov_b32 s34, 0x280000
    s_mov_b32 s35, 0x20000
    s_mov_b32 s36, s20
    s_and_b32 s37, s21, 0xffff
    s_mov_b32 s38, 0x21c000
    s_mov_b32 s39, 0x20000
    s_mov_b32 s40, s28
    s_and_b32 s41, s29, 0xffff
    s_mov_b32 s42, 0x2000000
    s_mov_b32 s43, 0x20000
    s_mov_b32 s72, s22
    s_and_b32 s73, s23, 0xffff
    s_mov_b32 s74, 0x21c000
    s_mov_b32 s75, 0x20000
    s_mov_b32 s44, s24
    s_and_b32 s45, s25, 0xffff
    s_mov_b32 s46, 0x280000
    s_mov_b32 s47, 0x20000
    s_cmp_ge_u32 s30, 4
    s_cbranch_scc1 g_help
    s_setprio 3
    s_lshr_b32 s52, s30, 1
    s_and_b32 s53, s30, 1
    v_and_b32 v222, 15, v0
    v_lshrrev_b32 v223, 4, v0
    v_lshrrev_b32 v224, 1, v222
    v_xor_b32 v224, v224, v223
    v_lshlrev_b32 v224, 4, v224
    v_lshl_add_u32 v224, v222, 7, v224
    s_lshl_b32 s55, s52, 13
    v_add_u32 v224, s55, v224
    s_lshl_b32 s55, s52, 6
    v_xor_b32 v197, s55, v224
    v_xor_b32 v198, 64, v197
    v_add_u32 v199, 73728, v197
    v_add_u32 v200, 73728, v198
    v_lshrrev_b32 v224, 2, v222
    v_lshl_add_u32 v224, v223, 3, v224
    v_mul_u32_u24 v224, 320, v224
    v_and_b32 v225, 3, v0
    v_lshl_add_u32 v224, v225, 3, v224
    s_mul_i32 s55, s52, 10240
    s_add_u32 s55, s55, 16384
    v_add_u32 v224, s55, v224
    v_and_b32 v225, 1, v223
    v_lshlrev_b32 v225, 5, v225
    s_mul_i32 s55, s53, 192
    v_add3_u32 v201, v224, s55, v225
    v_sub_u32 v205, v224, v225
    v_add_u32 v205, s55, v205
    s_lshl_b32 s55, s53, 5
    v_xor_b32 v225, s55, v225
    v_add3_u32 v209, v224, v225, 64
    v_add_u32 v209, 64, v209
    s_mul_i32 s55, s52, -20480
    s_add_u32 s55, s55, 10240
    v_add_u32 v202, s55, v201
    v_add_u32 v203, 73728, v201
    v_add_u32 v204, 73728, v202
    v_add_u32 v206, s55, v205
    v_add_u32 v207, 73728, v205
    v_add_u32 v208, 73728, v206
    v_add_u32 v210, s55, v209
    v_add_u32 v211, 73728, v209
    v_add_u32 v212, 73728, v210
    s_cmp_eq_u32 s61, 10
    s_cselect_b32 s58, s53, 0
    s_lshl_b32 s55, s52, 9
    v_lshlrev_b32 v229, 3, v222
    v_add_u32 v229, s55, v229
    v_add_u32 v229, 147456, v229
    v_lshlrev_b32 v225, 5, v223
    v_add_u32 v225, 148480, v225
    s_lshl_b32 s55, s53, 7
    v_add_u32 v226, s55, v225
    s_mul_i32 s55, s53, 768
    v_add_u32 v227, s55, v225
    s_lshl_b32 s55, s58, 8
    v_subrev_u32 v228, s55, v227
    v_lshlrev_b32 v233, 4, v0
    s_lshl_b32 s55, s60, 1
    s_add_u32 s55, s55, s52
    s_mul_i32 s55, s55, 221184
    s_mul_i32 s68, s61, 5120
    s_add_u32 s55, s55, s68
    s_mul_i32 s68, s53, 3072
    s_add_u32 s68, s68, s55
    s_mul_i32 s69, s53, 110592
    s_add_u32 s69, s69, s55
    s_lshl_b32 s59, s52, 12
    s_add_u32 s59, s59, 151552
    v_add_u32 v230, s59, v233
    s_lshl_b32 s59, s53, 3
    v_add_u32 v231, s59, v230
    s_lshl_b32 s59, s53, 11
    v_add_u32 v230, s59, v230
    v_mov_b32 v232, 159744
    v_mov_b32 v224, 0
    ds_write_b32 v232, v224
    s_barrier
    ds_read_b128 v[84:87], v197 offset:0
    ds_read_b128 v[88:91], v197 offset:2048
    ds_read_b128 v[92:95], v197 offset:4096
    ds_read_b128 v[96:99], v197 offset:6144
    ds_read_b64_tr_b16 v[116:117], v201 offset:0
    ds_read_b64_tr_b16 v[118:119], v201 offset:1280
    ds_read_b64_tr_b16 v[120:121], v205 offset:32
    ds_read_b64_tr_b16 v[122:123], v205 offset:1312
    ds_read_b64_tr_b16 v[124:125], v201 offset:64
    ds_read_b64_tr_b16 v[126:127], v201 offset:1344
    ds_read_b64_tr_b16 v[128:129], v205 offset:96
    ds_read_b64_tr_b16 v[130:131], v205 offset:1376
    ds_read_b64_tr_b16 v[132:133], v209 offset:0
    ds_read_b64_tr_b16 v[134:135], v209 offset:1280
    s_waitcnt lgkmcnt(8)
    v_mfma_f32_16x16x32_bf16 v[4:7], v[116:119], v[84:87], 0
    ds_read_b128 v[100:103], v198 offset:0
    v_mfma_f32_16x16x32_bf16 v[8:11], v[116:119], v[88:91], 0
    ds_read_b128 v[104:107], v198 offset:2048
    v_mfma_f32_16x16x32_bf16 v[12:15], v[116:119], v[92:95], 0
    ds_read_b128 v[108:111], v198 offset:4096
    v_mfma_f32_16x16x32_bf16 v[16:19], v[116:119], v[96:99], 0
    ds_read_b128 v[112:115], v198 offset:6144
    s_waitcnt lgkmcnt(4)
    v_mfma_f32_16x16x32_bf16 v[20:23], v[120:123], v[84:87], 0
    ds_read_b64_tr_b16 v[136:137], v202 offset:0
    v_mfma_f32_16x16x32_bf16 v[24:27], v[120:123], v[88:91], 0
    ds_read_b64_tr_b16 v[138:139], v202 offset:1280
    v_mfma_f32_16x16x32_bf16 v[28:31], v[120:123], v[92:95], 0
    ds_read_b64_tr_b16 v[140:141], v206 offset:32
    v_mfma_f32_16x16x32_bf16 v[32:35], v[120:123], v[96:99], 0
    ds_read_b64_tr_b16 v[142:143], v206 offset:1312
    v_mfma_f32_16x16x32_bf16 v[36:39], v[124:127], v[84:87], 0
    ds_read_b64_tr_b16 v[144:145], v202 offset:64
    v_mfma_f32_16x16x32_bf16 v[40:43], v[124:127], v[88:91], 0
    ds_read_b64_tr_b16 v[146:147], v202 offset:1344
    v_mfma_f32_16x16x32_bf16 v[44:47], v[124:127], v[92:95], 0
    ds_read_b64_tr_b16 v[148:149], v206 offset:96
    v_mfma_f32_16x16x32_bf16 v[48:51], v[124:127], v[96:99], 0
    ds_read_b64_tr_b16 v[150:151], v206 offset:1376
    v_mfma_f32_16x16x32_bf16 v[52:55], v[128:131], v[84:87], 0
    ds_read_b64_tr_b16 v[152:153], v210 offset:0
    v_mfma_f32_16x16x32_bf16 v[56:59], v[128:131], v[88:91], 0
    ds_read_b64_tr_b16 v[154:155], v210 offset:1280
    v_mfma_f32_16x16x32_bf16 v[60:63], v[128:131], v[92:95], 0
    v_mfma_f32_16x16x32_bf16 v[64:67], v[128:131], v[96:99], 0
    v_mfma_f32_16x16x32_bf16 v[68:71], v[132:135], v[84:87], 0
    v_mfma_f32_16x16x32_bf16 v[72:75], v[132:135], v[88:91], 0
    v_mfma_f32_16x16x32_bf16 v[76:79], v[132:135], v[92:95], 0
    v_mfma_f32_16x16x32_bf16 v[80:83], v[132:135], v[96:99], 0
    s_waitcnt lgkmcnt(0)
    s_barrier
    s_waitcnt lgkmcnt(8)
    v_mfma_f32_16x16x32_bf16 v[4:7], v[136:139], v[100:103], v[4:7]
    ds_read_b128 v[84:87], v197 offset:36864
    v_mfma_f32_16x16x32_bf16 v[8:11], v[136:139], v[104:107], v[8:11]
    ds_read_b128 v[88:91], v197 offset:38912
    v_mfma_f32_16x16x32_bf16 v[12:15], v[136:139], v[108:111], v[12:15]
    ds_read_b128 v[92:95], v197 offset:40960
    v_mfma_f32_16x16x32_bf16 v[16:19], v[136:139], v[112:115], v[16:19]
    ds_read_b128 v[96:99], v197 offset:43008
    s_waitcnt lgkmcnt(4)
    v_mfma_f32_16x16x32_bf16 v[20:23], v[140:143], v[100:103], v[20:23]
    ds_read_b64_tr_b16 v[116:117], v201 offset:36864
    v_mfma_f32_16x16x32_bf16 v[24:27], v[140:143], v[104:107], v[24:27]
    ds_read_b64_tr_b16 v[118:119], v201 offset:38144
    v_mfma_f32_16x16x32_bf16 v[28:31], v[140:143], v[108:111], v[28:31]
    ds_read_b64_tr_b16 v[120:121], v205 offset:36896
    v_mfma_f32_16x16x32_bf16 v[32:35], v[140:143], v[112:115], v[32:35]
    ds_read_b64_tr_b16 v[122:123], v205 offset:38176
    v_mfma_f32_16x16x32_bf16 v[36:39], v[144:147], v[100:103], v[36:39]
    ds_read_b64_tr_b16 v[124:125], v201 offset:36928
    v_mfma_f32_16x16x32_bf16 v[40:43], v[144:147], v[104:107], v[40:43]
    ds_read_b64_tr_b16 v[126:127], v201 offset:38208
    v_mfma_f32_16x16x32_bf16 v[44:47], v[144:147], v[108:111], v[44:47]
    ds_read_b64_tr_b16 v[128:129], v205 offset:36960
    v_mfma_f32_16x16x32_bf16 v[48:51], v[144:147], v[112:115], v[48:51]
    ds_read_b64_tr_b16 v[130:131], v205 offset:38240
    v_mfma_f32_16x16x32_bf16 v[52:55], v[148:151], v[100:103], v[52:55]
    ds_read_b64_tr_b16 v[132:133], v209 offset:36864
    v_mfma_f32_16x16x32_bf16 v[56:59], v[148:151], v[104:107], v[56:59]
    ds_read_b64_tr_b16 v[134:135], v209 offset:38144
    v_mfma_f32_16x16x32_bf16 v[60:63], v[148:151], v[108:111], v[60:63]
    v_mfma_f32_16x16x32_bf16 v[64:67], v[148:151], v[112:115], v[64:67]
    v_mfma_f32_16x16x32_bf16 v[68:71], v[152:155], v[100:103], v[68:71]
    v_mfma_f32_16x16x32_bf16 v[72:75], v[152:155], v[104:107], v[72:75]
    v_mfma_f32_16x16x32_bf16 v[76:79], v[152:155], v[108:111], v[76:79]
    v_mfma_f32_16x16x32_bf16 v[80:83], v[152:155], v[112:115], v[80:83]
    s_waitcnt lgkmcnt(8)
    v_mfma_f32_16x16x32_bf16 v[4:7], v[116:119], v[84:87], v[4:7]
    ds_read_b128 v[100:103], v198 offset:36864
    v_mfma_f32_16x16x32_bf16 v[8:11], v[116:119], v[88:91], v[8:11]
    ds_read_b128 v[104:107], v198 offset:38912
    v_mfma_f32_16x16x32_bf16 v[12:15], v[116:119], v[92:95], v[12:15]
    ds_read_b128 v[108:111], v198 offset:40960
    v_mfma_f32_16x16x32_bf16 v[16:19], v[116:119], v[96:99], v[16:19]
    ds_read_b128 v[112:115], v198 offset:43008
    s_waitcnt lgkmcnt(4)
    v_mfma_f32_16x16x32_bf16 v[20:23], v[120:123], v[84:87], v[20:23]
    ds_read_b64_tr_b16 v[136:137], v202 offset:36864
    v_mfma_f32_16x16x32_bf16 v[24:27], v[120:123], v[88:91], v[24:27]
    ds_read_b64_tr_b16 v[138:139], v202 offset:38144
    v_mfma_f32_16x16x32_bf16 v[28:31], v[120:123], v[92:95], v[28:31]
    ds_read_b64_tr_b16 v[140:141], v206 offset:36896
    v_mfma_f32_16x16x32_bf16 v[32:35], v[120:123], v[96:99], v[32:35]
    ds_read_b64_tr_b16 v[142:143], v206 offset:38176
    v_mfma_f32_16x16x32_bf16 v[36:39], v[124:127], v[84:87], v[36:39]
    ds_read_b64_tr_b16 v[144:145], v202 offset:36928
    v_mfma_f32_16x16x32_bf16 v[40:43], v[124:127], v[88:91], v[40:43]
    ds_read_b64_tr_b16 v[146:147], v202 offset:38208
    v_mfma_f32_16x16x32_bf16 v[44:47], v[124:127], v[92:95], v[44:47]
    ds_read_b64_tr_b16 v[148:149], v206 offset:36960
    v_mfma_f32_16x16x32_bf16 v[48:51], v[124:127], v[96:99], v[48:51]
    ds_read_b64_tr_b16 v[150:151], v206 offset:38240
    v_mfma_f32_16x16x32_bf16 v[52:55], v[128:131], v[84:87], v[52:55]
    ds_read_b64_tr_b16 v[152:153], v210 offset:36864
    v_mfma_f32_16x16x32_bf16 v[56:59], v[128:131], v[88:91], v[56:59]
    ds_read_b64_tr_b16 v[154:155], v210 offset:38144
    v_mfma_f32_16x16x32_bf16 v[60:63], v[128:131], v[92:95], v[60:63]
    v_mfma_f32_16x16x32_bf16 v[64:67], v[128:131], v[96:99], v[64:67]
    v_mfma_f32_16x16x32_bf16 v[68:71], v[132:135], v[84:87], v[68:71]
    v_mfma_f32_16x16x32_bf16 v[72:75], v[132:135], v[88:91], v[72:75]
    v_mfma_f32_16x16x32_bf16 v[76:79], v[132:135], v[92:95], v[76:79]
    v_mfma_f32_16x16x32_bf16 v[80:83], v[132:135], v[96:99], v[80:83]
    s_waitcnt lgkmcnt(0)
    s_barrier
    s_waitcnt lgkmcnt(8)
    v_mfma_f32_16x16x32_bf16 v[4:7], v[136:139], v[100:103], v[4:7]
    ds_read_b128 v[84:87], v199 offset:0
    v_mfma_f32_16x16x32_bf16 v[8:11], v[136:139], v[104:107], v[8:11]
    ds_read_b128 v[88:91], v199 offset:2048
    v_mfma_f32_16x16x32_bf16 v[12:15], v[136:139], v[108:111], v[12:15]
    ds_read_b128 v[92:95], v199 offset:4096
    v_mfma_f32_16x16x32_bf16 v[16:19], v[136:139], v[112:115], v[16:19]
    ds_read_b128 v[96:99], v199 offset:6144
    s_waitcnt lgkmcnt(4)
    v_mfma_f32_16x16x32_bf16 v[20:23], v[140:143], v[100:103], v[20:23]
    ds_read_b64_tr_b16 v[116:117], v203 offset:0
    v_mfma_f32_16x16x32_bf16 v[24:27], v[140:143], v[104:107], v[24:27]
    ds_read_b64_tr_b16 v[118:119], v203 offset:1280
    v_mfma_f32_16x16x32_bf16 v[28:31], v[140:143], v[108:111], v[28:31]
    ds_read_b64_tr_b16 v[120:121], v207 offset:32
    v_mfma_f32_16x16x32_bf16 v[32:35], v[140:143], v[112:115], v[32:35]
    ds_read_b64_tr_b16 v[122:123], v207 offset:1312
    v_mfma_f32_16x16x32_bf16 v[36:39], v[144:147], v[100:103], v[36:39]
    ds_read_b64_tr_b16 v[124:125], v203 offset:64
    v_mfma_f32_16x16x32_bf16 v[40:43], v[144:147], v[104:107], v[40:43]
    ds_read_b64_tr_b16 v[126:127], v203 offset:1344
    v_mfma_f32_16x16x32_bf16 v[44:47], v[144:147], v[108:111], v[44:47]
    ds_read_b64_tr_b16 v[128:129], v207 offset:96
    v_mfma_f32_16x16x32_bf16 v[48:51], v[144:147], v[112:115], v[48:51]
    ds_read_b64_tr_b16 v[130:131], v207 offset:1376
    v_mfma_f32_16x16x32_bf16 v[52:55], v[148:151], v[100:103], v[52:55]
    ds_read_b64_tr_b16 v[132:133], v211 offset:0
    v_mfma_f32_16x16x32_bf16 v[56:59], v[148:151], v[104:107], v[56:59]
    ds_read_b64_tr_b16 v[134:135], v211 offset:1280
    v_mfma_f32_16x16x32_bf16 v[60:63], v[148:151], v[108:111], v[60:63]
    v_mfma_f32_16x16x32_bf16 v[64:67], v[148:151], v[112:115], v[64:67]
    v_mfma_f32_16x16x32_bf16 v[68:71], v[152:155], v[100:103], v[68:71]
    v_mfma_f32_16x16x32_bf16 v[72:75], v[152:155], v[104:107], v[72:75]
    v_mfma_f32_16x16x32_bf16 v[76:79], v[152:155], v[108:111], v[76:79]
    v_mfma_f32_16x16x32_bf16 v[80:83], v[152:155], v[112:115], v[80:83]
    s_waitcnt lgkmcnt(8)
    v_mfma_f32_16x16x32_bf16 v[4:7], v[116:119], v[84:87], v[4:7]
    ds_read_b128 v[100:103], v200 offset:0
    v_mfma_f32_16x16x32_bf16 v[8:11], v[116:119], v[88:91], v[8:11]
    ds_read_b128 v[104:107], v200 offset:2048
    v_mfma_f32_16x16x32_bf16 v[12:15], v[116:119], v[92:95], v[12:15]
    ds_read_b128 v[108:111], v200 offset:4096
    v_mfma_f32_16x16x32_bf16 v[16:19], v[116:119], v[96:99], v[16:19]
    ds_read_b128 v[112:115], v200 offset:6144
    s_waitcnt lgkmcnt(4)
    v_mfma_f32_16x16x32_bf16 v[20:23], v[120:123], v[84:87], v[20:23]
    ds_read_b64_tr_b16 v[136:137], v204 offset:0
    v_mfma_f32_16x16x32_bf16 v[24:27], v[120:123], v[88:91], v[24:27]
    ds_read_b64_tr_b16 v[138:139], v204 offset:1280
    v_mfma_f32_16x16x32_bf16 v[28:31], v[120:123], v[92:95], v[28:31]
    ds_read_b64_tr_b16 v[140:141], v208 offset:32
    v_mfma_f32_16x16x32_bf16 v[32:35], v[120:123], v[96:99], v[32:35]
    ds_read_b64_tr_b16 v[142:143], v208 offset:1312
    v_mfma_f32_16x16x32_bf16 v[36:39], v[124:127], v[84:87], v[36:39]
    ds_read_b64_tr_b16 v[144:145], v204 offset:64
    v_mfma_f32_16x16x32_bf16 v[40:43], v[124:127], v[88:91], v[40:43]
    ds_read_b64_tr_b16 v[146:147], v204 offset:1344
    v_mfma_f32_16x16x32_bf16 v[44:47], v[124:127], v[92:95], v[44:47]
    ds_read_b64_tr_b16 v[148:149], v208 offset:96
    v_mfma_f32_16x16x32_bf16 v[48:51], v[124:127], v[96:99], v[48:51]
    ds_read_b64_tr_b16 v[150:151], v208 offset:1376
    v_mfma_f32_16x16x32_bf16 v[52:55], v[128:131], v[84:87], v[52:55]
    ds_read_b64_tr_b16 v[152:153], v212 offset:0
    v_mfma_f32_16x16x32_bf16 v[56:59], v[128:131], v[88:91], v[56:59]
    ds_read_b64_tr_b16 v[154:155], v212 offset:1280
    v_mfma_f32_16x16x32_bf16 v[60:63], v[128:131], v[92:95], v[60:63]
    v_mfma_f32_16x16x32_bf16 v[64:67], v[128:131], v[96:99], v[64:67]
    v_mfma_f32_16x16x32_bf16 v[68:71], v[132:135], v[84:87], v[68:71]
    v_mfma_f32_16x16x32_bf16 v[72:75], v[132:135], v[88:91], v[72:75]
    v_mfma_f32_16x16x32_bf16 v[76:79], v[132:135], v[92:95], v[76:79]
    v_mfma_f32_16x16x32_bf16 v[80:83], v[132:135], v[96:99], v[80:83]
    s_waitcnt lgkmcnt(0)
    s_barrier
    s_waitcnt lgkmcnt(8)
    v_mfma_f32_16x16x32_bf16 v[4:7], v[136:139], v[100:103], v[4:7]
    ds_read_b128 v[84:87], v199 offset:36864
    v_mfma_f32_16x16x32_bf16 v[8:11], v[136:139], v[104:107], v[8:11]
    ds_read_b128 v[88:91], v199 offset:38912
    v_mfma_f32_16x16x32_bf16 v[12:15], v[136:139], v[108:111], v[12:15]
    ds_read_b128 v[92:95], v199 offset:40960
    v_mfma_f32_16x16x32_bf16 v[16:19], v[136:139], v[112:115], v[16:19]
    ds_read_b128 v[96:99], v199 offset:43008
    s_waitcnt lgkmcnt(4)
    v_mfma_f32_16x16x32_bf16 v[20:23], v[140:143], v[100:103], v[20:23]
    ds_read_b64_tr_b16 v[116:117], v203 offset:36864
    v_mfma_f32_16x16x32_bf16 v[24:27], v[140:143], v[104:107], v[24:27]
    ds_read_b64_tr_b16 v[118:119], v203 offset:38144
    v_mfma_f32_16x16x32_bf16 v[28:31], v[140:143], v[108:111], v[28:31]
    ds_read_b64_tr_b16 v[120:121], v207 offset:36896
    v_mfma_f32_16x16x32_bf16 v[32:35], v[140:143], v[112:115], v[32:35]
    ds_read_b64_tr_b16 v[122:123], v207 offset:38176
    v_mfma_f32_16x16x32_bf16 v[36:39], v[144:147], v[100:103], v[36:39]
    ds_read_b64_tr_b16 v[124:125], v203 offset:36928
    v_mfma_f32_16x16x32_bf16 v[40:43], v[144:147], v[104:107], v[40:43]
    ds_read_b64_tr_b16 v[126:127], v203 offset:38208
    v_mfma_f32_16x16x32_bf16 v[44:47], v[144:147], v[108:111], v[44:47]
    ds_read_b64_tr_b16 v[128:129], v207 offset:36960
    v_mfma_f32_16x16x32_bf16 v[48:51], v[144:147], v[112:115], v[48:51]
    ds_read_b64_tr_b16 v[130:131], v207 offset:38240
    v_mfma_f32_16x16x32_bf16 v[52:55], v[148:151], v[100:103], v[52:55]
    ds_read_b64_tr_b16 v[132:133], v211 offset:36864
    v_mfma_f32_16x16x32_bf16 v[56:59], v[148:151], v[104:107], v[56:59]
    ds_read_b64_tr_b16 v[134:135], v211 offset:38144
    v_mfma_f32_16x16x32_bf16 v[60:63], v[148:151], v[108:111], v[60:63]
    v_mfma_f32_16x16x32_bf16 v[64:67], v[148:151], v[112:115], v[64:67]
    v_mfma_f32_16x16x32_bf16 v[68:71], v[152:155], v[100:103], v[68:71]
    v_mfma_f32_16x16x32_bf16 v[72:75], v[152:155], v[104:107], v[72:75]
    v_mfma_f32_16x16x32_bf16 v[76:79], v[152:155], v[108:111], v[76:79]
    v_mfma_f32_16x16x32_bf16 v[80:83], v[152:155], v[112:115], v[80:83]
    s_waitcnt lgkmcnt(8)
    v_mfma_f32_16x16x32_bf16 v[4:7], v[116:119], v[84:87], v[4:7]
    ds_read_b128 v[100:103], v200 offset:36864
    v_mfma_f32_16x16x32_bf16 v[8:11], v[116:119], v[88:91], v[8:11]
    ds_read_b128 v[104:107], v200 offset:38912
    v_mfma_f32_16x16x32_bf16 v[12:15], v[116:119], v[92:95], v[12:15]
    ds_read_b128 v[108:111], v200 offset:40960
    v_mfma_f32_16x16x32_bf16 v[16:19], v[116:119], v[96:99], v[16:19]
    ds_read_b128 v[112:115], v200 offset:43008
    s_waitcnt lgkmcnt(4)
    v_mfma_f32_16x16x32_bf16 v[20:23], v[120:123], v[84:87], v[20:23]
    ds_read_b64_tr_b16 v[136:137], v204 offset:36864
    v_mfma_f32_16x16x32_bf16 v[24:27], v[120:123], v[88:91], v[24:27]
    ds_read_b64_tr_b16 v[138:139], v204 offset:38144
    v_mfma_f32_16x16x32_bf16 v[28:31], v[120:123], v[92:95], v[28:31]
    ds_read_b64_tr_b16 v[140:141], v208 offset:36896
    v_mfma_f32_16x16x32_bf16 v[32:35], v[120:123], v[96:99], v[32:35]
    ds_read_b64_tr_b16 v[142:143], v208 offset:38176
    v_mfma_f32_16x16x32_bf16 v[36:39], v[124:127], v[84:87], v[36:39]
    ds_read_b64_tr_b16 v[144:145], v204 offset:36928
    v_mfma_f32_16x16x32_bf16 v[40:43], v[124:127], v[88:91], v[40:43]
    ds_read_b64_tr_b16 v[146:147], v204 offset:38208
    v_mfma_f32_16x16x32_bf16 v[44:47], v[124:127], v[92:95], v[44:47]
    ds_read_b64_tr_b16 v[148:149], v208 offset:36960
    v_mfma_f32_16x16x32_bf16 v[48:51], v[124:127], v[96:99], v[48:51]
    ds_read_b64_tr_b16 v[150:151], v208 offset:38240
    v_mfma_f32_16x16x32_bf16 v[52:55], v[128:131], v[84:87], v[52:55]
    ds_read_b64_tr_b16 v[152:153], v212 offset:36864
    v_mfma_f32_16x16x32_bf16 v[56:59], v[128:131], v[88:91], v[56:59]
    ds_read_b64_tr_b16 v[154:155], v212 offset:38144
    v_mfma_f32_16x16x32_bf16 v[60:63], v[128:131], v[92:95], v[60:63]
    v_mfma_f32_16x16x32_bf16 v[64:67], v[128:131], v[96:99], v[64:67]
    v_mfma_f32_16x16x32_bf16 v[68:71], v[132:135], v[84:87], v[68:71]
    v_mfma_f32_16x16x32_bf16 v[72:75], v[132:135], v[88:91], v[72:75]
    v_mfma_f32_16x16x32_bf16 v[76:79], v[132:135], v[92:95], v[76:79]
    v_mfma_f32_16x16x32_bf16 v[80:83], v[132:135], v[96:99], v[80:83]
    s_waitcnt lgkmcnt(0)
    s_barrier
    s_waitcnt lgkmcnt(8)
    v_mfma_f32_16x16x32_bf16 v[4:7], v[136:139], v[100:103], v[4:7]
    ds_read_b128 v[84:87], v197 offset:0
    v_mfma_f32_16x16x32_bf16 v[8:11], v[136:139], v[104:107], v[8:11]
    ds_read_b128 v[88:91], v197 offset:2048
    v_mfma_f32_16x16x32_bf16 v[12:15], v[136:139], v[108:111], v[12:15]
    ds_read_b128 v[92:95], v197 offset:4096
    v_mfma_f32_16x16x32_bf16 v[16:19], v[136:139], v[112:115], v[16:19]
    ds_read_b128 v[96:99], v197 offset:6144
    s_waitcnt lgkmcnt(4)
    v_mfma_f32_16x16x32_bf16 v[20:23], v[140:143], v[100:103], v[20:23]
    ds_read_b64_tr_b16 v[116:117], v201 offset:0
    v_mfma_f32_16x16x32_bf16 v[24:27], v[140:143], v[104:107], v[24:27]
    ds_read_b64_tr_b16 v[118:119], v201 offset:1280
    v_mfma_f32_16x16x32_bf16 v[28:31], v[140:143], v[108:111], v[28:31]
    ds_read_b64_tr_b16 v[120:121], v205 offset:32
    v_mfma_f32_16x16x32_bf16 v[32:35], v[140:143], v[112:115], v[32:35]
    ds_read_b64_tr_b16 v[122:123], v205 offset:1312
    v_mfma_f32_16x16x32_bf16 v[36:39], v[144:147], v[100:103], v[36:39]
    ds_read_b64_tr_b16 v[124:125], v201 offset:64
    v_mfma_f32_16x16x32_bf16 v[40:43], v[144:147], v[104:107], v[40:43]
    ds_read_b64_tr_b16 v[126:127], v201 offset:1344
    v_mfma_f32_16x16x32_bf16 v[44:47], v[144:147], v[108:111], v[44:47]
    ds_read_b64_tr_b16 v[128:129], v205 offset:96
    v_mfma_f32_16x16x32_bf16 v[48:51], v[144:147], v[112:115], v[48:51]
    ds_read_b64_tr_b16 v[130:131], v205 offset:1376
    v_mfma_f32_16x16x32_bf16 v[52:55], v[148:151], v[100:103], v[52:55]
    ds_read_b64_tr_b16 v[132:133], v209 offset:0
    v_mfma_f32_16x16x32_bf16 v[56:59], v[148:151], v[104:107], v[56:59]
    ds_read_b64_tr_b16 v[134:135], v209 offset:1280
    v_mfma_f32_16x16x32_bf16 v[60:63], v[148:151], v[108:111], v[60:63]
    v_mfma_f32_16x16x32_bf16 v[64:67], v[148:151], v[112:115], v[64:67]
    v_mfma_f32_16x16x32_bf16 v[68:71], v[152:155], v[100:103], v[68:71]
    v_mfma_f32_16x16x32_bf16 v[72:75], v[152:155], v[104:107], v[72:75]
    v_mfma_f32_16x16x32_bf16 v[76:79], v[152:155], v[108:111], v[76:79]
    v_mfma_f32_16x16x32_bf16 v[80:83], v[152:155], v[112:115], v[80:83]
    s_waitcnt lgkmcnt(8)
    v_mfma_f32_16x16x32_bf16 v[4:7], v[116:119], v[84:87], v[4:7]
    ds_read_b128 v[100:103], v198 offset:0
    v_mfma_f32_16x16x32_bf16 v[8:11], v[116:119], v[88:91], v[8:11]
    ds_read_b128 v[104:107], v198 offset:2048
    v_mfma_f32_16x16x32_bf16 v[12:15], v[116:119], v[92:95], v[12:15]
    ds_read_b128 v[108:111], v198 offset:4096
    v_mfma_f32_16x16x32_bf16 v[16:19], v[116:119], v[96:99], v[16:19]
    ds_read_b128 v[112:115], v198 offset:6144
    s_waitcnt lgkmcnt(4)
    v_mfma_f32_16x16x32_bf16 v[20:23], v[120:123], v[84:87], v[20:23]
    ds_read_b64_tr_b16 v[136:137], v202 offset:0
    v_mfma_f32_16x16x32_bf16 v[24:27], v[120:123], v[88:91], v[24:27]
    ds_read_b64_tr_b16 v[138:139], v202 offset:1280
    v_mfma_f32_16x16x32_bf16 v[28:31], v[120:123], v[92:95], v[28:31]
    ds_read_b64_tr_b16 v[140:141], v206 offset:32
    v_mfma_f32_16x16x32_bf16 v[32:35], v[120:123], v[96:99], v[32:35]
    ds_read_b64_tr_b16 v[142:143], v206 offset:1312
    v_mfma_f32_16x16x32_bf16 v[36:39], v[124:127], v[84:87], v[36:39]
    ds_read_b64_tr_b16 v[144:145], v202 offset:64
    v_mfma_f32_16x16x32_bf16 v[40:43], v[124:127], v[88:91], v[40:43]
    ds_read_b64_tr_b16 v[146:147], v202 offset:1344
    v_mfma_f32_16x16x32_bf16 v[44:47], v[124:127], v[92:95], v[44:47]
    ds_read_b64_tr_b16 v[148:149], v206 offset:96
    v_mfma_f32_16x16x32_bf16 v[48:51], v[124:127], v[96:99], v[48:51]
    ds_read_b64_tr_b16 v[150:151], v206 offset:1376
    v_mfma_f32_16x16x32_bf16 v[52:55], v[128:131], v[84:87], v[52:55]
    ds_read_b64_tr_b16 v[152:153], v210 offset:0
    v_mfma_f32_16x16x32_bf16 v[56:59], v[128:131], v[88:91], v[56:59]
    ds_read_b64_tr_b16 v[154:155], v210 offset:1280
    v_mfma_f32_16x16x32_bf16 v[60:63], v[128:131], v[92:95], v[60:63]
    v_mfma_f32_16x16x32_bf16 v[64:67], v[128:131], v[96:99], v[64:67]
    v_mfma_f32_16x16x32_bf16 v[68:71], v[132:135], v[84:87], v[68:71]
    v_mfma_f32_16x16x32_bf16 v[72:75], v[132:135], v[88:91], v[72:75]
    v_mfma_f32_16x16x32_bf16 v[76:79], v[132:135], v[92:95], v[76:79]
    v_mfma_f32_16x16x32_bf16 v[80:83], v[132:135], v[96:99], v[80:83]
    s_waitcnt lgkmcnt(0)
    s_barrier
    s_waitcnt lgkmcnt(8)
    v_mfma_f32_16x16x32_bf16 v[4:7], v[136:139], v[100:103], v[4:7]
    ds_read_b128 v[84:87], v197 offset:36864
    v_mfma_f32_16x16x32_bf16 v[8:11], v[136:139], v[104:107], v[8:11]
    ds_read_b128 v[88:91], v197 offset:38912
    v_mfma_f32_16x16x32_bf16 v[12:15], v[136:139], v[108:111], v[12:15]
    ds_read_b128 v[92:95], v197 offset:40960
    v_mfma_f32_16x16x32_bf16 v[16:19], v[136:139], v[112:115], v[16:19]
    ds_read_b128 v[96:99], v197 offset:43008
    s_waitcnt lgkmcnt(4)
    v_mfma_f32_16x16x32_bf16 v[20:23], v[140:143], v[100:103], v[20:23]
    ds_read_b64_tr_b16 v[116:117], v201 offset:36864
    v_mfma_f32_16x16x32_bf16 v[24:27], v[140:143], v[104:107], v[24:27]
    ds_read_b64_tr_b16 v[118:119], v201 offset:38144
    v_mfma_f32_16x16x32_bf16 v[28:31], v[140:143], v[108:111], v[28:31]
    ds_read_b64_tr_b16 v[120:121], v205 offset:36896
    v_mfma_f32_16x16x32_bf16 v[32:35], v[140:143], v[112:115], v[32:35]
    ds_read_b64_tr_b16 v[122:123], v205 offset:38176
    v_mfma_f32_16x16x32_bf16 v[36:39], v[144:147], v[100:103], v[36:39]
    ds_read_b64_tr_b16 v[124:125], v201 offset:36928
    v_mfma_f32_16x16x32_bf16 v[40:43], v[144:147], v[104:107], v[40:43]
    ds_read_b64_tr_b16 v[126:127], v201 offset:38208
    v_mfma_f32_16x16x32_bf16 v[44:47], v[144:147], v[108:111], v[44:47]
    ds_read_b64_tr_b16 v[128:129], v205 offset:36960
    v_mfma_f32_16x16x32_bf16 v[48:51], v[144:147], v[112:115], v[48:51]
    ds_read_b64_tr_b16 v[130:131], v205 offset:38240
    v_mfma_f32_16x16x32_bf16 v[52:55], v[148:151], v[100:103], v[52:55]
    ds_read_b64_tr_b16 v[132:133], v209 offset:36864
    v_mfma_f32_16x16x32_bf16 v[56:59], v[148:151], v[104:107], v[56:59]
    ds_read_b64_tr_b16 v[134:135], v209 offset:38144
    v_mfma_f32_16x16x32_bf16 v[60:63], v[148:151], v[108:111], v[60:63]
    v_mfma_f32_16x16x32_bf16 v[64:67], v[148:151], v[112:115], v[64:67]
    v_mfma_f32_16x16x32_bf16 v[68:71], v[152:155], v[100:103], v[68:71]
    v_mfma_f32_16x16x32_bf16 v[72:75], v[152:155], v[104:107], v[72:75]
    v_mfma_f32_16x16x32_bf16 v[76:79], v[152:155], v[108:111], v[76:79]
    v_mfma_f32_16x16x32_bf16 v[80:83], v[152:155], v[112:115], v[80:83]
    v_mov_b32 v224, 0
    global_load_dword v196, v224, s[26:27] sc1
    s_waitcnt lgkmcnt(8)
    v_mfma_f32_16x16x32_bf16 v[4:7], v[116:119], v[84:87], v[4:7]
    ds_read_b128 v[100:103], v198 offset:36864
    v_mfma_f32_16x16x32_bf16 v[8:11], v[116:119], v[88:91], v[8:11]
    ds_read_b128 v[104:107], v198 offset:38912
    v_mfma_f32_16x16x32_bf16 v[12:15], v[116:119], v[92:95], v[12:15]
    ds_read_b128 v[108:111], v198 offset:40960
    v_mfma_f32_16x16x32_bf16 v[16:19], v[116:119], v[96:99], v[16:19]
    ds_read_b128 v[112:115], v198 offset:43008
    s_waitcnt lgkmcnt(4)
    v_mfma_f32_16x16x32_bf16 v[20:23], v[120:123], v[84:87], v[20:23]
    ds_read_b64_tr_b16 v[136:137], v202 offset:36864
    v_mfma_f32_16x16x32_bf16 v[24:27], v[120:123], v[88:91], v[24:27]
    ds_read_b64_tr_b16 v[138:139], v202 offset:38144
    v_mfma_f32_16x16x32_bf16 v[28:31], v[120:123], v[92:95], v[28:31]
    ds_read_b64_tr_b16 v[140:141], v206 offset:36896
    v_mfma_f32_16x16x32_bf16 v[32:35], v[120:123], v[96:99], v[32:35]
    ds_read_b64_tr_b16 v[142:143], v206 offset:38176
    v_mfma_f32_16x16x32_bf16 v[36:39], v[124:127], v[84:87], v[36:39]
    ds_read_b64_tr_b16 v[144:145], v202 offset:36928
    v_mfma_f32_16x16x32_bf16 v[40:43], v[124:127], v[88:91], v[40:43]
    ds_read_b64_tr_b16 v[146:147], v202 offset:38208
    v_mfma_f32_16x16x32_bf16 v[44:47], v[124:127], v[92:95], v[44:47]
    ds_read_b64_tr_b16 v[148:149], v206 offset:36960
    v_mfma_f32_16x16x32_bf16 v[48:51], v[124:127], v[96:99], v[48:51]
    ds_read_b64_tr_b16 v[150:151], v206 offset:38240
    v_mfma_f32_16x16x32_bf16 v[52:55], v[128:131], v[84:87], v[52:55]
    ds_read_b64_tr_b16 v[152:153], v210 offset:36864
    v_mfma_f32_16x16x32_bf16 v[56:59], v[128:131], v[88:91], v[56:59]
    ds_read_b64_tr_b16 v[154:155], v210 offset:38144
    v_mfma_f32_16x16x32_bf16 v[60:63], v[128:131], v[92:95], v[60:63]
    v_mfma_f32_16x16x32_bf16 v[64:67], v[128:131], v[96:99], v[64:67]
    v_mfma_f32_16x16x32_bf16 v[68:71], v[132:135], v[84:87], v[68:71]
    v_mfma_f32_16x16x32_bf16 v[72:75], v[132:135], v[88:91], v[72:75]
    v_mfma_f32_16x16x32_bf16 v[76:79], v[132:135], v[92:95], v[76:79]
    v_mfma_f32_16x16x32_bf16 v[80:83], v[132:135], v[96:99], v[80:83]
    s_waitcnt lgkmcnt(0)
    s_barrier
    s_waitcnt lgkmcnt(8)
    v_mfma_f32_16x16x32_bf16 v[4:7], v[136:139], v[100:103], v[4:7]
    ds_read_b128 v[84:87], v199 offset:0
    v_mfma_f32_16x16x32_bf16 v[8:11], v[136:139], v[104:107], v[8:11]
    ds_read_b128 v[88:91], v199 offset:2048
    v_mfma_f32_16x16x32_bf16 v[12:15], v[136:139], v[108:111], v[12:15]
    ds_read_b128 v[92:95], v199 offset:4096
    v_mfma_f32_16x16x32_bf16 v[16:19], v[136:139], v[112:115], v[16:19]
    ds_read_b128 v[96:99], v199 offset:6144
    s_waitcnt lgkmcnt(4)
    v_mfma_f32_16x16x32_bf16 v[20:23], v[140:143], v[100:103], v[20:23]
    ds_read_b64_tr_b16 v[116:117], v203 offset:0
    v_mfma_f32_16x16x32_bf16 v[24:27], v[140:143], v[104:107], v[24:27]
    ds_read_b64_tr_b16 v[118:119], v203 offset:1280
    v_mfma_f32_16x16x32_bf16 v[28:31], v[140:143], v[108:111], v[28:31]
    ds_read_b64_tr_b16 v[120:121], v207 offset:32
    v_mfma_f32_16x16x32_bf16 v[32:35], v[140:143], v[112:115], v[32:35]
    ds_read_b64_tr_b16 v[122:123], v207 offset:1312
    v_mfma_f32_16x16x32_bf16 v[36:39], v[144:147], v[100:103], v[36:39]
    ds_read_b64_tr_b16 v[124:125], v203 offset:64
    v_mfma_f32_16x16x32_bf16 v[40:43], v[144:147], v[104:107], v[40:43]
    ds_read_b64_tr_b16 v[126:127], v203 offset:1344
    v_mfma_f32_16x16x32_bf16 v[44:47], v[144:147], v[108:111], v[44:47]
    ds_read_b64_tr_b16 v[128:129], v207 offset:96
    v_mfma_f32_16x16x32_bf16 v[48:51], v[144:147], v[112:115], v[48:51]
    ds_read_b64_tr_b16 v[130:131], v207 offset:1376
    v_mfma_f32_16x16x32_bf16 v[52:55], v[148:151], v[100:103], v[52:55]
    ds_read_b64_tr_b16 v[132:133], v211 offset:0
    v_mfma_f32_16x16x32_bf16 v[56:59], v[148:151], v[104:107], v[56:59]
    ds_read_b64_tr_b16 v[134:135], v211 offset:1280
    v_mfma_f32_16x16x32_bf16 v[60:63], v[148:151], v[108:111], v[60:63]
    v_mfma_f32_16x16x32_bf16 v[64:67], v[148:151], v[112:115], v[64:67]
    v_mfma_f32_16x16x32_bf16 v[68:71], v[152:155], v[100:103], v[68:71]
    v_mfma_f32_16x16x32_bf16 v[72:75], v[152:155], v[104:107], v[72:75]
    v_mfma_f32_16x16x32_bf16 v[76:79], v[152:155], v[108:111], v[76:79]
    v_mfma_f32_16x16x32_bf16 v[80:83], v[152:155], v[112:115], v[80:83]
    s_waitcnt lgkmcnt(8)
    v_mfma_f32_16x16x32_bf16 v[4:7], v[116:119], v[84:87], v[4:7]
    ds_read_b128 v[100:103], v200 offset:0
    v_mfma_f32_16x16x32_bf16 v[8:11], v[116:119], v[88:91], v[8:11]
    ds_read_b128 v[104:107], v200 offset:2048
    v_mfma_f32_16x16x32_bf16 v[12:15], v[116:119], v[92:95], v[12:15]
    ds_read_b128 v[108:111], v200 offset:4096
    v_mfma_f32_16x16x32_bf16 v[16:19], v[116:119], v[96:99], v[16:19]
    ds_read_b128 v[112:115], v200 offset:6144
    s_waitcnt lgkmcnt(4)
    v_mfma_f32_16x16x32_bf16 v[20:23], v[120:123], v[84:87], v[20:23]
    ds_read_b64_tr_b16 v[136:137], v204 offset:0
    v_mfma_f32_16x16x32_bf16 v[24:27], v[120:123], v[88:91], v[24:27]
    ds_read_b64_tr_b16 v[138:139], v204 offset:1280
    v_mfma_f32_16x16x32_bf16 v[28:31], v[120:123], v[92:95], v[28:31]
    ds_read_b64_tr_b16 v[140:141], v208 offset:32
    v_mfma_f32_16x16x32_bf16 v[32:35], v[120:123], v[96:99], v[32:35]
    ds_read_b64_tr_b16 v[142:143], v208 offset:1312
    v_mfma_f32_16x16x32_bf16 v[36:39], v[124:127], v[84:87], v[36:39]
    ds_read_b64_tr_b16 v[144:145], v204 offset:64
    v_mfma_f32_16x16x32_bf16 v[40:43], v[124:127], v[88:91], v[40:43]
    ds_read_b64_tr_b16 v[146:147], v204 offset:1344
    v_mfma_f32_16x16x32_bf16 v[44:47], v[124:127], v[92:95], v[44:47]
    ds_read_b64_tr_b16 v[148:149], v208 offset:96
    v_mfma_f32_16x16x32_bf16 v[48:51], v[124:127], v[96:99], v[48:51]
    ds_read_b64_tr_b16 v[150:151], v208 offset:1376
    v_mfma_f32_16x16x32_bf16 v[52:55], v[128:131], v[84:87], v[52:55]
    ds_read_b64_tr_b16 v[152:153], v212 offset:0
    v_mfma_f32_16x16x32_bf16 v[56:59], v[128:131], v[88:91], v[56:59]
    ds_read_b64_tr_b16 v[154:155], v212 offset:1280
    v_mfma_f32_16x16x32_bf16 v[60:63], v[128:131], v[92:95], v[60:63]
    v_mfma_f32_16x16x32_bf16 v[64:67], v[128:131], v[96:99], v[64:67]
    v_mfma_f32_16x16x32_bf16 v[68:71], v[132:135], v[84:87], v[68:71]
    v_mfma_f32_16x16x32_bf16 v[72:75], v[132:135], v[88:91], v[72:75]
    v_mfma_f32_16x16x32_bf16 v[76:79], v[132:135], v[92:95], v[76:79]
    v_mfma_f32_16x16x32_bf16 v[80:83], v[132:135], v[96:99], v[80:83]
    s_waitcnt lgkmcnt(0)
    s_barrier
    s_waitcnt lgkmcnt(8)
    v_mfma_f32_16x16x32_bf16 v[4:7], v[136:139], v[100:103], v[4:7]
    ds_read_b128 v[84:87], v199 offset:36864
    v_mfma_f32_16x16x32_bf16 v[8:11], v[136:139], v[104:107], v[8:11]
    ds_read_b128 v[88:91], v199 offset:38912
    v_mfma_f32_16x16x32_bf16 v[12:15], v[136:139], v[108:111], v[12:15]
    ds_read_b128 v[92:95], v199 offset:40960
    v_mfma_f32_16x16x32_bf16 v[16:19], v[136:139], v[112:115], v[16:19]
    ds_read_b128 v[96:99], v199 offset:43008
    s_waitcnt lgkmcnt(4)
    v_mfma_f32_16x16x32_bf16 v[20:23], v[140:143], v[100:103], v[20:23]
    ds_read_b64_tr_b16 v[116:117], v203 offset:36864
    v_mfma_f32_16x16x32_bf16 v[24:27], v[140:143], v[104:107], v[24:27]
    ds_read_b64_tr_b16 v[118:119], v203 offset:38144
    v_mfma_f32_16x16x32_bf16 v[28:31], v[140:143], v[108:111], v[28:31]
    ds_read_b64_tr_b16 v[120:121], v207 offset:36896
    v_mfma_f32_16x16x32_bf16 v[32:35], v[140:143], v[112:115], v[32:35]
    ds_read_b64_tr_b16 v[122:123], v207 offset:38176
    v_mfma_f32_16x16x32_bf16 v[36:39], v[144:147], v[100:103], v[36:39]
    ds_read_b64_tr_b16 v[124:125], v203 offset:36928
    v_mfma_f32_16x16x32_bf16 v[40:43], v[144:147], v[104:107], v[40:43]
    ds_read_b64_tr_b16 v[126:127], v203 offset:38208
    v_mfma_f32_16x16x32_bf16 v[44:47], v[144:147], v[108:111], v[44:47]
    ds_read_b64_tr_b16 v[128:129], v207 offset:36960
    v_mfma_f32_16x16x32_bf16 v[48:51], v[144:147], v[112:115], v[48:51]
    ds_read_b64_tr_b16 v[130:131], v207 offset:38240
    v_mfma_f32_16x16x32_bf16 v[52:55], v[148:151], v[100:103], v[52:55]
    ds_read_b64_tr_b16 v[132:133], v211 offset:36864
    v_mfma_f32_16x16x32_bf16 v[56:59], v[148:151], v[104:107], v[56:59]
    ds_read_b64_tr_b16 v[134:135], v211 offset:38144
    v_mfma_f32_16x16x32_bf16 v[60:63], v[148:151], v[108:111], v[60:63]
    v_mfma_f32_16x16x32_bf16 v[64:67], v[148:151], v[112:115], v[64:67]
    v_mfma_f32_16x16x32_bf16 v[68:71], v[152:155], v[100:103], v[68:71]
    v_mfma_f32_16x16x32_bf16 v[72:75], v[152:155], v[104:107], v[72:75]
    v_mfma_f32_16x16x32_bf16 v[76:79], v[152:155], v[108:111], v[76:79]
    v_mfma_f32_16x16x32_bf16 v[80:83], v[152:155], v[112:115], v[80:83]
    s_waitcnt lgkmcnt(8)
    v_mfma_f32_16x16x32_bf16 v[4:7], v[116:119], v[84:87], v[4:7]
    ds_read_b128 v[100:103], v200 offset:36864
    v_mfma_f32_16x16x32_bf16 v[8:11], v[116:119], v[88:91], v[8:11]
    ds_read_b128 v[104:107], v200 offset:38912
    v_mfma_f32_16x16x32_bf16 v[12:15], v[116:119], v[92:95], v[12:15]
    ds_read_b128 v[108:111], v200 offset:40960
    v_mfma_f32_16x16x32_bf16 v[16:19], v[116:119], v[96:99], v[16:19]
    ds_read_b128 v[112:115], v200 offset:43008
    s_waitcnt lgkmcnt(4)
    v_mfma_f32_16x16x32_bf16 v[20:23], v[120:123], v[84:87], v[20:23]
    ds_read_b64_tr_b16 v[136:137], v204 offset:36864
    v_mfma_f32_16x16x32_bf16 v[24:27], v[120:123], v[88:91], v[24:27]
    ds_read_b64_tr_b16 v[138:139], v204 offset:38144
    v_mfma_f32_16x16x32_bf16 v[28:31], v[120:123], v[92:95], v[28:31]
    ds_read_b64_tr_b16 v[140:141], v208 offset:36896
    v_mfma_f32_16x16x32_bf16 v[32:35], v[120:123], v[96:99], v[32:35]
    ds_read_b64_tr_b16 v[142:143], v208 offset:38176
    v_mfma_f32_16x16x32_bf16 v[36:39], v[124:127], v[84:87], v[36:39]
    ds_read_b64_tr_b16 v[144:145], v204 offset:36928
    v_mfma_f32_16x16x32_bf16 v[40:43], v[124:127], v[88:91], v[40:43]
    ds_read_b64_tr_b16 v[146:147], v204 offset:38208
    v_mfma_f32_16x16x32_bf16 v[44:47], v[124:127], v[92:95], v[44:47]
    ds_read_b64_tr_b16 v[148:149], v208 offset:36960
    v_mfma_f32_16x16x32_bf16 v[48:51], v[124:127], v[96:99], v[48:51]
    ds_read_b64_tr_b16 v[150:151], v208 offset:38240
    v_mfma_f32_16x16x32_bf16 v[52:55], v[128:131], v[84:87], v[52:55]
    ds_read_b64_tr_b16 v[152:153], v212 offset:36864
    v_mfma_f32_16x16x32_bf16 v[56:59], v[128:131], v[88:91], v[56:59]
    ds_read_b64_tr_b16 v[154:155], v212 offset:38144
    v_mfma_f32_16x16x32_bf16 v[60:63], v[128:131], v[92:95], v[60:63]
    v_mfma_f32_16x16x32_bf16 v[64:67], v[128:131], v[96:99], v[64:67]
    v_mfma_f32_16x16x32_bf16 v[68:71], v[132:135], v[84:87], v[68:71]
    v_mfma_f32_16x16x32_bf16 v[72:75], v[132:135], v[88:91], v[72:75]
    v_mfma_f32_16x16x32_bf16 v[76:79], v[132:135], v[92:95], v[76:79]
    v_mfma_f32_16x16x32_bf16 v[80:83], v[132:135], v[96:99], v[80:83]
    s_waitcnt lgkmcnt(0)
    s_barrier
    s_waitcnt lgkmcnt(8)
    v_mfma_f32_16x16x32_bf16 v[4:7], v[136:139], v[100:103], v[4:7]
    ds_read_b128 v[84:87], v197 offset:0
    v_mfma_f32_16x16x32_bf16 v[8:11], v[136:139], v[104:107], v[8:11]
    ds_read_b128 v[88:91], v197 offset:2048
    v_mfma_f32_16x16x32_bf16 v[12:15], v[136:139], v[108:111], v[12:15]
    ds_read_b128 v[92:95], v197 offset:4096
    v_mfma_f32_16x16x32_bf16 v[16:19], v[136:139], v[112:115], v[16:19]
    ds_read_b128 v[96:99], v197 offset:6144
    s_waitcnt lgkmcnt(4)
    v_mfma_f32_16x16x32_bf16 v[20:23], v[140:143], v[100:103], v[20:23]
    ds_read_b64_tr_b16 v[116:117], v201 offset:0
    v_mfma_f32_16x16x32_bf16 v[24:27], v[140:143], v[104:107], v[24:27]
    ds_read_b64_tr_b16 v[118:119], v201 offset:1280
    v_mfma_f32_16x16x32_bf16 v[28:31], v[140:143], v[108:111], v[28:31]
    ds_read_b64_tr_b16 v[120:121], v205 offset:32
    v_mfma_f32_16x16x32_bf16 v[32:35], v[140:143], v[112:115], v[32:35]
    ds_read_b64_tr_b16 v[122:123], v205 offset:1312
    v_mfma_f32_16x16x32_bf16 v[36:39], v[144:147], v[100:103], v[36:39]
    ds_read_b64_tr_b16 v[124:125], v201 offset:64
    v_mfma_f32_16x16x32_bf16 v[40:43], v[144:147], v[104:107], v[40:43]
    ds_read_b64_tr_b16 v[126:127], v201 offset:1344
    v_mfma_f32_16x16x32_bf16 v[44:47], v[144:147], v[108:111], v[44:47]
    ds_read_b64_tr_b16 v[128:129], v205 offset:96
    v_mfma_f32_16x16x32_bf16 v[48:51], v[144:147], v[112:115], v[48:51]
    ds_read_b64_tr_b16 v[130:131], v205 offset:1376
    v_mfma_f32_16x16x32_bf16 v[52:55], v[148:151], v[100:103], v[52:55]
    ds_read_b64_tr_b16 v[132:133], v209 offset:0
    v_mfma_f32_16x16x32_bf16 v[56:59], v[148:151], v[104:107], v[56:59]
    ds_read_b64_tr_b16 v[134:135], v209 offset:1280
    v_mfma_f32_16x16x32_bf16 v[60:63], v[148:151], v[108:111], v[60:63]
    v_mfma_f32_16x16x32_bf16 v[64:67], v[148:151], v[112:115], v[64:67]
    v_mfma_f32_16x16x32_bf16 v[68:71], v[152:155], v[100:103], v[68:71]
    v_mfma_f32_16x16x32_bf16 v[72:75], v[152:155], v[104:107], v[72:75]
    v_mfma_f32_16x16x32_bf16 v[76:79], v[152:155], v[108:111], v[76:79]
    v_mfma_f32_16x16x32_bf16 v[80:83], v[152:155], v[112:115], v[80:83]
    s_waitcnt lgkmcnt(8)
    v_mfma_f32_16x16x32_bf16 v[4:7], v[116:119], v[84:87], v[4:7]
    ds_read_b128 v[100:103], v198 offset:0
    v_mfma_f32_16x16x32_bf16 v[8:11], v[116:119], v[88:91], v[8:11]
    ds_read_b128 v[104:107], v198 offset:2048
    v_mfma_f32_16x16x32_bf16 v[12:15], v[116:119], v[92:95], v[12:15]
    ds_read_b128 v[108:111], v198 offset:4096
    v_mfma_f32_16x16x32_bf16 v[16:19], v[116:119], v[96:99], v[16:19]
    ds_read_b128 v[112:115], v198 offset:6144
    s_waitcnt lgkmcnt(4)
    v_mfma_f32_16x16x32_bf16 v[20:23], v[120:123], v[84:87], v[20:23]
    ds_read_b64_tr_b16 v[136:137], v202 offset:0
    v_mfma_f32_16x16x32_bf16 v[24:27], v[120:123], v[88:91], v[24:27]
    ds_read_b64_tr_b16 v[138:139], v202 offset:1280
    v_mfma_f32_16x16x32_bf16 v[28:31], v[120:123], v[92:95], v[28:31]
    ds_read_b64_tr_b16 v[140:141], v206 offset:32
    v_mfma_f32_16x16x32_bf16 v[32:35], v[120:123], v[96:99], v[32:35]
    ds_read_b64_tr_b16 v[142:143], v206 offset:1312
    v_mfma_f32_16x16x32_bf16 v[36:39], v[124:127], v[84:87], v[36:39]
    ds_read_b64_tr_b16 v[144:145], v202 offset:64
    v_mfma_f32_16x16x32_bf16 v[40:43], v[124:127], v[88:91], v[40:43]
    ds_read_b64_tr_b16 v[146:147], v202 offset:1344
    v_mfma_f32_16x16x32_bf16 v[44:47], v[124:127], v[92:95], v[44:47]
    ds_read_b64_tr_b16 v[148:149], v206 offset:96
    v_mfma_f32_16x16x32_bf16 v[48:51], v[124:127], v[96:99], v[48:51]
    ds_read_b64_tr_b16 v[150:151], v206 offset:1376
    v_mfma_f32_16x16x32_bf16 v[52:55], v[128:131], v[84:87], v[52:55]
    ds_read_b64_tr_b16 v[152:153], v210 offset:0
    v_mfma_f32_16x16x32_bf16 v[56:59], v[128:131], v[88:91], v[56:59]
    ds_read_b64_tr_b16 v[154:155], v210 offset:1280
    v_mfma_f32_16x16x32_bf16 v[60:63], v[128:131], v[92:95], v[60:63]
    v_mfma_f32_16x16x32_bf16 v[64:67], v[128:131], v[96:99], v[64:67]
    v_mfma_f32_16x16x32_bf16 v[68:71], v[132:135], v[84:87], v[68:71]
    v_mfma_f32_16x16x32_bf16 v[72:75], v[132:135], v[88:91], v[72:75]
    v_mfma_f32_16x16x32_bf16 v[76:79], v[132:135], v[92:95], v[76:79]
    v_mfma_f32_16x16x32_bf16 v[80:83], v[132:135], v[96:99], v[80:83]
    s_waitcnt lgkmcnt(0)
    s_barrier
    s_waitcnt lgkmcnt(8)
    v_mfma_f32_16x16x32_bf16 v[4:7], v[136:139], v[100:103], v[4:7]
    ds_read_b128 v[84:87], v197 offset:36864
    v_mfma_f32_16x16x32_bf16 v[8:11], v[136:139], v[104:107], v[8:11]
    ds_read_b128 v[88:91], v197 offset:38912
    v_mfma_f32_16x16x32_bf16 v[12:15], v[136:139], v[108:111], v[12:15]
    ds_read_b128 v[92:95], v197 offset:40960
    v_mfma_f32_16x16x32_bf16 v[16:19], v[136:139], v[112:115], v[16:19]
    ds_read_b128 v[96:99], v197 offset:43008
    s_waitcnt lgkmcnt(4)
    v_mfma_f32_16x16x32_bf16 v[20:23], v[140:143], v[100:103], v[20:23]
    ds_read_b64_tr_b16 v[116:117], v201 offset:36864
    v_mfma_f32_16x16x32_bf16 v[24:27], v[140:143], v[104:107], v[24:27]
    ds_read_b64_tr_b16 v[118:119], v201 offset:38144
    v_mfma_f32_16x16x32_bf16 v[28:31], v[140:143], v[108:111], v[28:31]
    ds_read_b64_tr_b16 v[120:121], v205 offset:36896
    v_mfma_f32_16x16x32_bf16 v[32:35], v[140:143], v[112:115], v[32:35]
    ds_read_b64_tr_b16 v[122:123], v205 offset:38176
    v_mfma_f32_16x16x32_bf16 v[36:39], v[144:147], v[100:103], v[36:39]
    ds_read_b64_tr_b16 v[124:125], v201 offset:36928
    v_mfma_f32_16x16x32_bf16 v[40:43], v[144:147], v[104:107], v[40:43]
    ds_read_b64_tr_b16 v[126:127], v201 offset:38208
    v_mfma_f32_16x16x32_bf16 v[44:47], v[144:147], v[108:111], v[44:47]
    ds_read_b64_tr_b16 v[128:129], v205 offset:36960
    v_mfma_f32_16x16x32_bf16 v[48:51], v[144:147], v[112:115], v[48:51]
    ds_read_b64_tr_b16 v[130:131], v205 offset:38240
    v_mfma_f32_16x16x32_bf16 v[52:55], v[148:151], v[100:103], v[52:55]
    ds_read_b64_tr_b16 v[132:133], v209 offset:36864
    v_mfma_f32_16x16x32_bf16 v[56:59], v[148:151], v[104:107], v[56:59]
    ds_read_b64_tr_b16 v[134:135], v209 offset:38144
    v_mfma_f32_16x16x32_bf16 v[60:63], v[148:151], v[108:111], v[60:63]
    v_mfma_f32_16x16x32_bf16 v[64:67], v[148:151], v[112:115], v[64:67]
    v_mfma_f32_16x16x32_bf16 v[68:71], v[152:155], v[100:103], v[68:71]
    v_mfma_f32_16x16x32_bf16 v[72:75], v[152:155], v[104:107], v[72:75]
    v_mfma_f32_16x16x32_bf16 v[76:79], v[152:155], v[108:111], v[76:79]
    v_mfma_f32_16x16x32_bf16 v[80:83], v[152:155], v[112:115], v[80:83]
    s_waitcnt lgkmcnt(8)
    v_mfma_f32_16x16x32_bf16 v[4:7], v[116:119], v[84:87], v[4:7]
    ds_read_b128 v[100:103], v198 offset:36864
    v_mfma_f32_16x16x32_bf16 v[8:11], v[116:119], v[88:91], v[8:11]
    ds_read_b128 v[104:107], v198 offset:38912
    v_mfma_f32_16x16x32_bf16 v[12:15], v[116:119], v[92:95], v[12:15]
    ds_read_b128 v[108:111], v198 offset:40960
    v_mfma_f32_16x16x32_bf16 v[16:19], v[116:119], v[96:99], v[16:19]
    ds_read_b128 v[112:115], v198 offset:43008
    s_waitcnt lgkmcnt(4)
    v_mfma_f32_16x16x32_bf16 v[20:23], v[120:123], v[84:87], v[20:23]
    ds_read_b64_tr_b16 v[136:137], v202 offset:36864
    v_mfma_f32_16x16x32_bf16 v[24:27], v[120:123], v[88:91], v[24:27]
    ds_read_b64_tr_b16 v[138:139], v202 offset:38144
    v_mfma_f32_16x16x32_bf16 v[28:31], v[120:123], v[92:95], v[28:31]
    ds_read_b64_tr_b16 v[140:141], v206 offset:36896
    v_mfma_f32_16x16x32_bf16 v[32:35], v[120:123], v[96:99], v[32:35]
    ds_read_b64_tr_b16 v[142:143], v206 offset:38176
    v_mfma_f32_16x16x32_bf16 v[36:39], v[124:127], v[84:87], v[36:39]
    ds_read_b64_tr_b16 v[144:145], v202 offset:36928
    v_mfma_f32_16x16x32_bf16 v[40:43], v[124:127], v[88:91], v[40:43]
    ds_read_b64_tr_b16 v[146:147], v202 offset:38208
    v_mfma_f32_16x16x32_bf16 v[44:47], v[124:127], v[92:95], v[44:47]
    ds_read_b64_tr_b16 v[148:149], v206 offset:36960
    v_mfma_f32_16x16x32_bf16 v[48:51], v[124:127], v[96:99], v[48:51]
    ds_read_b64_tr_b16 v[150:151], v206 offset:38240
    v_mfma_f32_16x16x32_bf16 v[52:55], v[128:131], v[84:87], v[52:55]
    ds_read_b64_tr_b16 v[152:153], v210 offset:36864
    v_mfma_f32_16x16x32_bf16 v[56:59], v[128:131], v[88:91], v[56:59]
    ds_read_b64_tr_b16 v[154:155], v210 offset:38144
    v_mfma_f32_16x16x32_bf16 v[60:63], v[128:131], v[92:95], v[60:63]
    v_mfma_f32_16x16x32_bf16 v[64:67], v[128:131], v[96:99], v[64:67]
    v_mfma_f32_16x16x32_bf16 v[68:71], v[132:135], v[84:87], v[68:71]
    v_mfma_f32_16x16x32_bf16 v[72:75], v[132:135], v[88:91], v[72:75]
    v_mfma_f32_16x16x32_bf16 v[76:79], v[132:135], v[92:95], v[76:79]
    v_mfma_f32_16x16x32_bf16 v[80:83], v[132:135], v[96:99], v[80:83]
    s_barrier
    s_waitcnt lgkmcnt(8)
    v_mfma_f32_16x16x32_bf16 v[4:7], v[136:139], v[100:103], v[4:7]
    ds_read_b64 v[214:215], v229 offset:0
    v_mfma_f32_16x16x32_bf16 v[8:11], v[136:139], v[104:107], v[8:11]
    ds_read_b64 v[216:217], v229 offset:128
    v_mfma_f32_16x16x32_bf16 v[12:15], v[136:139], v[108:111], v[12:15]
    ds_read_b64 v[218:219], v229 offset:256
    v_mfma_f32_16x16x32_bf16 v[16:19], v[136:139], v[112:115], v[16:19]
    ds_read_b64 v[220:221], v229 offset:384
    s_waitcnt lgkmcnt(4)
    v_mfma_f32_16x16x32_bf16 v[20:23], v[140:143], v[100:103], v[20:23]
    ds_read_b128 v[188:191], v226 offset:512
    v_mfma_f32_16x16x32_bf16 v[24:27], v[140:143], v[104:107], v[24:27]
    ds_read_b128 v[192:195], v226 offset:528
    v_mfma_f32_16x16x32_bf16 v[28:31], v[140:143], v[108:111], v[28:31]
    ds_read_b128 v[156:159], v227 offset:0
    v_mfma_f32_16x16x32_bf16 v[32:35], v[140:143], v[112:115], v[32:35]
    ds_read_b128 v[160:163], v227 offset:16
    v_mfma_f32_16x16x32_bf16 v[36:39], v[144:147], v[100:103], v[36:39]
    ds_read_b128 v[164:167], v227 offset:128
    v_mfma_f32_16x16x32_bf16 v[40:43], v[144:147], v[104:107], v[40:43]
    ds_read_b128 v[168:171], v227 offset:144
    v_mfma_f32_16x16x32_bf16 v[44:47], v[144:147], v[108:111], v[44:47]
    ds_read_b128 v[172:175], v228 offset:256
    v_mfma_f32_16x16x32_bf16 v[48:51], v[144:147], v[112:115], v[48:51]
    ds_read_b128 v[176:179], v228 offset:272
    v_mfma_f32_16x16x32_bf16 v[52:55], v[148:151], v[100:103], v[52:55]
    ds_read_b128 v[180:183], v228 offset:384
    v_mfma_f32_16x16x32_bf16 v[56:59], v[148:151], v[104:107], v[56:59]
    ds_read_b128 v[184:187], v228 offset:400
    v_mfma_f32_16x16x32_bf16 v[60:63], v[148:151], v[108:111], v[60:63]
    v_mfma_f32_16x16x32_bf16 v[64:67], v[148:151], v[112:115], v[64:67]
    v_mfma_f32_16x16x32_bf16 v[68:71], v[152:155], v[100:103], v[68:71]
    v_mfma_f32_16x16x32_bf16 v[72:75], v[152:155], v[104:107], v[72:75]
    v_mfma_f32_16x16x32_bf16 v[76:79], v[152:155], v[108:111], v[76:79]
    v_mfma_f32_16x16x32_bf16 v[80:83], v[152:155], v[112:115], v[80:83]
    s_waitcnt vmcnt(0)
nz_lp_8:
    v_readfirstlane_b32 s67, v196
    s_cmp_lg_u32 s67, 0
    s_cbranch_scc1 nz_ok_7
    v_mov_b32 v224, 0
    global_load_dword v196, v224, s[26:27] sc1
    s_waitcnt vmcnt(0)
    s_branch nz_lp_8
nz_ok_7:
    s_waitcnt lgkmcnt(0)
g1_chk_10:
    v_min3_u32 v224, v215, v217, v219
    v_min3_u32 v224, v224, v221, v158
    v_min3_u32 v224, v224, v162, v166
    v_min3_u32 v224, v224, v170, v174
    v_min3_u32 v224, v224, v178, v182
    v_min3_u32 v224, v224, v186, v190
    v_min3_u32 v224, v224, v194, v194
    v_max3_u32 v225, v215, v217, v219
    v_max3_u32 v225, v225, v221, v158
    v_max3_u32 v225, v225, v162, v166
    v_max3_u32 v225, v225, v170, v174
    v_max3_u32 v225, v225, v178, v182
    v_max3_u32 v225, v225, v186, v190
    v_max3_u32 v225, v225, v194, v194
    v_cmp_ne_u32 vcc, s67, v224
    s_cbranch_vccnz g1_retry_9
    v_cmp_ne_u32 vcc, s67, v225
    s_cbranch_vccnz g1_retry_9
    s_branch g1_ok_11
g1_retry_9:
    s_lshl_b32 s55, s60, 1
    s_add_u32 s55, s55, s52
    s_lshl_b32 s55, s55, 9
    s_add_u32 s55, s55, 0x700000
    v_lshlrev_b32 v224, 3, v222
    buffer_load_dwordx2 v[214:215], v224, s[40:43], s55 offen offset:0 sc1
    buffer_load_dwordx2 v[216:217], v224, s[40:43], s55 offen offset:128 sc1
    buffer_load_dwordx2 v[218:219], v224, s[40:43], s55 offen offset:256 sc1
    buffer_load_dwordx2 v[220:221], v224, s[40:43], s55 offen offset:384 sc1
    s_mul_i32 s55, s61, 1280
    s_add_u32 s55, s55, 0x708000
    s_lshl_b32 s56, s53, 7
    s_add_u32 s56, s56, s55
    s_mul_i32 s57, s53, 768
    s_add_u32 s55, s55, s57
    s_lshl_b32 s57, s58, 8
    s_sub_u32 s57, s55, s57
    v_lshlrev_b32 v225, 5, v223
    buffer_load_dwordx4 v[156:159], v225, s[40:43], s55 offen offset:0 sc1
    buffer_load_dwordx4 v[160:163], v225, s[40:43], s55 offen offset:16 sc1
    buffer_load_dwordx4 v[164:167], v225, s[40:43], s55 offen offset:128 sc1
    buffer_load_dwordx4 v[168:171], v225, s[40:43], s55 offen offset:144 sc1
    buffer_load_dwordx4 v[172:175], v225, s[40:43], s57 offen offset:256 sc1
    buffer_load_dwordx4 v[176:179], v225, s[40:43], s57 offen offset:272 sc1
    buffer_load_dwordx4 v[180:183], v225, s[40:43], s57 offen offset:384 sc1
    buffer_load_dwordx4 v[184:187], v225, s[40:43], s57 offen offset:400 sc1
    buffer_load_dwordx4 v[188:191], v225, s[40:43], s56 offen offset:512 sc1
    buffer_load_dwordx4 v[192:195], v225, s[40:43], s56 offen offset:528 sc1
    s_waitcnt vmcnt(0)
    s_branch g1_chk_10
g1_ok_11:
    v_and_b32 v215, 0xffff0000, v214
    v_rcp_f32 v215, v215
    v_lshlrev_b32 v214, 16, v214
    v_mul_f32 v214, -v214, v215
    v_and_b32 v217, 0xffff0000, v216
    v_rcp_f32 v217, v217
    v_lshlrev_b32 v216, 16, v216
    v_mul_f32 v216, -v216, v217
    v_and_b32 v219, 0xffff0000, v218
    v_rcp_f32 v219, v219
    v_lshlrev_b32 v218, 16, v218
    v_mul_f32 v218, -v218, v219
    v_and_b32 v221, 0xffff0000, v220
    v_rcp_f32 v221, v221
    v_lshlrev_b32 v220, 16, v220
    v_mul_f32 v220, -v220, v221
    v_pk_mul_f32 v[108:109], v[156:157], v[214:215] op_sel_hi:[1,0]
    v_pk_fma_f32 v[108:109], v[4:5], v[214:215], v[108:109] op_sel:[0,1,0] op_sel_hi:[1,1,1]
    v_cvt_pk_bf16_f32 v84, v108, v109
    v_pk_max_i16 v84, v84, 0
    v_pk_mul_f32 v[110:111], v[160:161], v[214:215] op_sel_hi:[1,0]
    v_pk_fma_f32 v[110:111], v[6:7], v[214:215], v[110:111] op_sel:[0,1,0] op_sel_hi:[1,1,1]
    v_cvt_pk_bf16_f32 v85, v110, v111
    v_pk_max_i16 v85, v85, 0
    v_pk_mul_f32 v[112:113], v[164:165], v[214:215] op_sel_hi:[1,0]
    v_pk_fma_f32 v[112:113], v[20:21], v[214:215], v[112:113] op_sel:[0,1,0] op_sel_hi:[1,1,1]
    v_cvt_pk_bf16_f32 v86, v112, v113
    v_pk_max_i16 v86, v86, 0
    v_pk_mul_f32 v[114:115], v[168:169], v[214:215] op_sel_hi:[1,0]
    v_pk_fma_f32 v[114:115], v[22:23], v[214:215], v[114:115] op_sel:[0,1,0] op_sel_hi:[1,1,1]
    v_cvt_pk_bf16_f32 v87, v114, v115
    v_pk_max_i16 v87, v87, 0
    s_add_u32 s55, s68, 0
    buffer_store_dwordx4 v[84:87], v233, s[40:43], s55 offen offset:0 sc1
    v_pk_mul_f32 v[108:109], v[156:157], v[216:217] op_sel_hi:[1,0]
    v_pk_fma_f32 v[108:109], v[8:9], v[216:217], v[108:109] op_sel:[0,1,0] op_sel_hi:[1,1,1]
    v_cvt_pk_bf16_f32 v88, v108, v109
    v_pk_max_i16 v88, v88, 0
    v_pk_mul_f32 v[110:111], v[160:161], v[216:217] op_sel_hi:[1,0]
    v_pk_fma_f32 v[110:111], v[10:11], v[216:217], v[110:111] op_sel:[0,1,0] op_sel_hi:[1,1,1]
    v_cvt_pk_bf16_f32 v89, v110, v111
    v_pk_max_i16 v89, v89, 0
    v_pk_mul_f32 v[112:113], v[164:165], v[216:217] op_sel_hi:[1,0]
    v_pk_fma_f32 v[112:113], v[24:25], v[216:217], v[112:113] op_sel:[0,1,0] op_sel_hi:[1,1,1]
    v_cvt_pk_bf16_f32 v90, v112, v113
    v_pk_max_i16 v90, v90, 0
    v_pk_mul_f32 v[114:115], v[168:169], v[216:217] op_sel_hi:[1,0]
    v_pk_fma_f32 v[114:115], v[26:27], v[216:217], v[114:115] op_sel:[0,1,0] op_sel_hi:[1,1,1]
    v_cvt_pk_bf16_f32 v91, v114, v115
    v_pk_max_i16 v91, v91, 0
    s_add_u32 s55, s68, 55296
    buffer_store_dwordx4 v[88:91], v233, s[40:43], s55 offen offset:0 sc1
    v_pk_mul_f32 v[108:109], v[156:157], v[218:219] op_sel_hi:[1,0]
    v_pk_fma_f32 v[108:109], v[12:13], v[218:219], v[108:109] op_sel:[0,1,0] op_sel_hi:[1,1,1]
    v_cvt_pk_bf16_f32 v92, v108, v109
    v_pk_max_i16 v92, v92, 0
    v_pk_mul_f32 v[110:111], v[160:161], v[218:219] op_sel_hi:[1,0]
    v_pk_fma_f32 v[110:111], v[14:15], v[218:219], v[110:111] op_sel:[0,1,0] op_sel_hi:[1,1,1]
    v_cvt_pk_bf16_f32 v93, v110, v111
    v_pk_max_i16 v93, v93, 0
    v_pk_mul_f32 v[112:113], v[164:165], v[218:219] op_sel_hi:[1,0]
    v_pk_fma_f32 v[112:113], v[28:29], v[218:219], v[112:113] op_sel:[0,1,0] op_sel_hi:[1,1,1]
    v_cvt_pk_bf16_f32 v94, v112, v113
    v_pk_max_i16 v94, v94, 0
    v_pk_mul_f32 v[114:115], v[168:169], v[218:219] op_sel_hi:[1,0]
    v_pk_fma_f32 v[114:115], v[30:31], v[218:219], v[114:115] op_sel:[0,1,0] op_sel_hi:[1,1,1]
    v_cvt_pk_bf16_f32 v95, v114, v115
    v_pk_max_i16 v95, v95, 0
    s_add_u32 s55, s68, 110592
    buffer_store_dwordx4 v[92:95], v233, s[40:43], s55 offen offset:0 sc1
    v_pk_mul_f32 v[108:109], v[156:157], v[220:221] op_sel_hi:[1,0]
    v_pk_fma_f32 v[108:109], v[16:17], v[220:221], v[108:109] op_sel:[0,1,0] op_sel_hi:[1,1,1]
    v_cvt_pk_bf16_f32 v96, v108, v109
    v_pk_max_i16 v96, v96, 0
    v_pk_mul_f32 v[110:111], v[160:161], v[220:221] op_sel_hi:[1,0]
    v_pk_fma_f32 v[110:111], v[18:19], v[220:221], v[110:111] op_sel:[0,1,0] op_sel_hi:[1,1,1]
    v_cvt_pk_bf16_f32 v97, v110, v111
    v_pk_max_i16 v97, v97, 0
    v_pk_mul_f32 v[112:113], v[164:165], v[220:221] op_sel_hi:[1,0]
    v_pk_fma_f32 v[112:113], v[32:33], v[220:221], v[112:113] op_sel:[0,1,0] op_sel_hi:[1,1,1]
    v_cvt_pk_bf16_f32 v98, v112, v113
    v_pk_max_i16 v98, v98, 0
    v_pk_mul_f32 v[114:115], v[168:169], v[220:221] op_sel_hi:[1,0]
    v_pk_fma_f32 v[114:115], v[34:35], v[220:221], v[114:115] op_sel:[0,1,0] op_sel_hi:[1,1,1]
    v_cvt_pk_bf16_f32 v99, v114, v115
    v_pk_max_i16 v99, v99, 0
    s_add_u32 s55, s68, 165888
    buffer_store_dwordx4 v[96:99], v233, s[40:43], s55 offen offset:0 sc1
    v_pk_mul_f32 v[108:109], v[188:189], v[214:215] op_sel_hi:[1,0]
    v_pk_fma_f32 v[108:109], v[68:69], v[214:215], v[108:109] op_sel:[0,1,0] op_sel_hi:[1,1,1]
    v_cvt_pk_bf16_f32 v116, v108, v109
    v_pk_max_i16 v116, v116, 0
    v_pk_mul_f32 v[110:111], v[192:193], v[214:215] op_sel_hi:[1,0]
    v_pk_fma_f32 v[110:111], v[70:71], v[214:215], v[110:111] op_sel:[0,1,0] op_sel_hi:[1,1,1]
    v_cvt_pk_bf16_f32 v117, v110, v111
    v_pk_max_i16 v117, v117, 0
    ds_write_b64 v231, v[116:117] offset:0
    v_pk_mul_f32 v[108:109], v[188:189], v[216:217] op_sel_hi:[1,0]
    v_pk_fma_f32 v[108:109], v[72:73], v[216:217], v[108:109] op_sel:[0,1,0] op_sel_hi:[1,1,1]
    v_cvt_pk_bf16_f32 v120, v108, v109
    v_pk_max_i16 v120, v120, 0
    v_pk_mul_f32 v[110:111], v[192:193], v[216:217] op_sel_hi:[1,0]
    v_pk_fma_f32 v[110:111], v[74:75], v[216:217], v[110:111] op_sel:[0,1,0] op_sel_hi:[1,1,1]
    v_cvt_pk_bf16_f32 v121, v110, v111
    v_pk_max_i16 v121, v121, 0
    ds_write_b64 v231, v[120:121] offset:1024
    v_pk_mul_f32 v[108:109], v[188:189], v[218:219] op_sel_hi:[1,0]
    v_pk_fma_f32 v[108:109], v[76:77], v[218:219], v[108:109] op_sel:[0,1,0] op_sel_hi:[1,1,1]
    v_cvt_pk_bf16_f32 v124, v108, v109
    v_pk_max_i16 v124, v124, 0
    v_pk_mul_f32 v[110:111], v[192:193], v[218:219] op_sel_hi:[1,0]
    v_pk_fma_f32 v[110:111], v[78:79], v[218:219], v[110:111] op_sel:[0,1,0] op_sel_hi:[1,1,1]
    v_cvt_pk_bf16_f32 v125, v110, v111
    v_pk_max_i16 v125, v125, 0
    ds_write_b64 v231, v[124:125] offset:2048
    v_pk_mul_f32 v[108:109], v[188:189], v[220:221] op_sel_hi:[1,0]
    v_pk_fma_f32 v[108:109], v[80:81], v[220:221], v[108:109] op_sel:[0,1,0] op_sel_hi:[1,1,1]
    v_cvt_pk_bf16_f32 v128, v108, v109
    v_pk_max_i16 v128, v128, 0
    v_pk_mul_f32 v[110:111], v[192:193], v[220:221] op_sel_hi:[1,0]
    v_pk_fma_f32 v[110:111], v[82:83], v[220:221], v[110:111] op_sel:[0,1,0] op_sel_hi:[1,1,1]
    v_cvt_pk_bf16_f32 v129, v110, v111
    v_pk_max_i16 v129, v129, 0
    ds_write_b64 v231, v[128:129] offset:3072
    s_cmp_lg_u32 s58, 0
    s_cbranch_scc1 g1_skip_12
    v_pk_mul_f32 v[108:109], v[172:173], v[214:215] op_sel_hi:[1,0]
    v_pk_fma_f32 v[108:109], v[36:37], v[214:215], v[108:109] op_sel:[0,1,0] op_sel_hi:[1,1,1]
    v_cvt_pk_bf16_f32 v100, v108, v109
    v_pk_max_i16 v100, v100, 0
    v_pk_mul_f32 v[110:111], v[176:177], v[214:215] op_sel_hi:[1,0]
    v_pk_fma_f32 v[110:111], v[38:39], v[214:215], v[110:111] op_sel:[0,1,0] op_sel_hi:[1,1,1]
    v_cvt_pk_bf16_f32 v101, v110, v111
    v_pk_max_i16 v101, v101, 0
    v_pk_mul_f32 v[112:113], v[180:181], v[214:215] op_sel_hi:[1,0]
    v_pk_fma_f32 v[112:113], v[52:53], v[214:215], v[112:113] op_sel:[0,1,0] op_sel_hi:[1,1,1]
    v_cvt_pk_bf16_f32 v102, v112, v113
    v_pk_max_i16 v102, v102, 0
    v_pk_mul_f32 v[114:115], v[184:185], v[214:215] op_sel_hi:[1,0]
    v_pk_fma_f32 v[114:115], v[54:55], v[214:215], v[114:115] op_sel:[0,1,0] op_sel_hi:[1,1,1]
    v_cvt_pk_bf16_f32 v103, v114, v115
    v_pk_max_i16 v103, v103, 0
    s_add_u32 s55, s68, 0
    buffer_store_dwordx4 v[100:103], v233, s[40:43], s55 offen offset:1024 sc1
    v_pk_mul_f32 v[108:109], v[172:173], v[216:217] op_sel_hi:[1,0]
    v_pk_fma_f32 v[108:109], v[40:41], v[216:217], v[108:109] op_sel:[0,1,0] op_sel_hi:[1,1,1]
    v_cvt_pk_bf16_f32 v104, v108, v109
    v_pk_max_i16 v104, v104, 0
    v_pk_mul_f32 v[110:111], v[176:177], v[216:217] op_sel_hi:[1,0]
    v_pk_fma_f32 v[110:111], v[42:43], v[216:217], v[110:111] op_sel:[0,1,0] op_sel_hi:[1,1,1]
    v_cvt_pk_bf16_f32 v105, v110, v111
    v_pk_max_i16 v105, v105, 0
    v_pk_mul_f32 v[112:113], v[180:181], v[216:217] op_sel_hi:[1,0]
    v_pk_fma_f32 v[112:113], v[56:57], v[216:217], v[112:113] op_sel:[0,1,0] op_sel_hi:[1,1,1]
    v_cvt_pk_bf16_f32 v106, v112, v113
    v_pk_max_i16 v106, v106, 0
    v_pk_mul_f32 v[114:115], v[184:185], v[216:217] op_sel_hi:[1,0]
    v_pk_fma_f32 v[114:115], v[58:59], v[216:217], v[114:115] op_sel:[0,1,0] op_sel_hi:[1,1,1]
    v_cvt_pk_bf16_f32 v107, v114, v115
    v_pk_max_i16 v107, v107, 0
    s_add_u32 s55, s68, 55296
    buffer_store_dwordx4 v[104:107], v233, s[40:43], s55 offen offset:1024 sc1
    v_pk_mul_f32 v[108:109], v[172:173], v[218:219] op_sel_hi:[1,0]
    v_pk_fma_f32 v[108:109], v[44:45], v[218:219], v[108:109] op_sel:[0,1,0] op_sel_hi:[1,1,1]
    v_cvt_pk_bf16_f32 v84, v108, v109
    v_pk_max_i16 v84, v84, 0
    v_pk_mul_f32 v[110:111], v[176:177], v[218:219] op_sel_hi:[1,0]
    v_pk_fma_f32 v[110:111], v[46:47], v[218:219], v[110:111] op_sel:[0,1,0] op_sel_hi:[1,1,1]
    v_cvt_pk_bf16_f32 v85, v110, v111
    v_pk_max_i16 v85, v85, 0
    v_pk_mul_f32 v[112:113], v[180:181], v[218:219] op_sel_hi:[1,0]
    v_pk_fma_f32 v[112:113], v[60:61], v[218:219], v[112:113] op_sel:[0,1,0] op_sel_hi:[1,1,1]
    v_cvt_pk_bf16_f32 v86, v112, v113
    v_pk_max_i16 v86, v86, 0
    v_pk_mul_f32 v[114:115], v[184:185], v[218:219] op_sel_hi:[1,0]
    v_pk_fma_f32 v[114:115], v[62:63], v[218:219], v[114:115] op_sel:[0,1,0] op_sel_hi:[1,1,1]
    v_cvt_pk_bf16_f32 v87, v114, v115
    v_pk_max_i16 v87, v87, 0
    s_add_u32 s55, s68, 110592
    buffer_store_dwordx4 v[84:87], v233, s[40:43], s55 offen offset:1024 sc1
    v_pk_mul_f32 v[108:109], v[172:173], v[220:221] op_sel_hi:[1,0]
    v_pk_fma_f32 v[108:109], v[48:49], v[220:221], v[108:109] op_sel:[0,1,0] op_sel_hi:[1,1,1]
    v_cvt_pk_bf16_f32 v88, v108, v109
    v_pk_max_i16 v88, v88, 0
    v_pk_mul_f32 v[110:111], v[176:177], v[220:221] op_sel_hi:[1,0]
    v_pk_fma_f32 v[110:111], v[50:51], v[220:221], v[110:111] op_sel:[0,1,0] op_sel_hi:[1,1,1]
    v_cvt_pk_bf16_f32 v89, v110, v111
    v_pk_max_i16 v89, v89, 0
    v_pk_mul_f32 v[112:113], v[180:181], v[220:221] op_sel_hi:[1,0]
    v_pk_fma_f32 v[112:113], v[64:65], v[220:221], v[112:113] op_sel:[0,1,0] op_sel_hi:[1,1,1]
    v_cvt_pk_bf16_f32 v90, v112, v113
    v_pk_max_i16 v90, v90, 0
    v_pk_mul_f32 v[114:115], v[184:185], v[220:221] op_sel_hi:[1,0]
    v_pk_fma_f32 v[114:115], v[66:67], v[220:221], v[114:115] op_sel:[0,1,0] op_sel_hi:[1,1,1]
    v_cvt_pk_bf16_f32 v91, v114, v115
    v_pk_max_i16 v91, v91, 0
    s_add_u32 s55, s68, 165888
    buffer_store_dwordx4 v[88:91], v233, s[40:43], s55 offen offset:1024 sc1
g1_skip_12:
    s_waitcnt lgkmcnt(0)
    s_barrier
    ds_read_b128 v[136:139], v230 offset:0
    ds_read_b128 v[140:143], v230 offset:1024
    s_waitcnt lgkmcnt(1)
    buffer_store_dwordx4 v[136:139], v233, s[40:43], s69 offen offset:2048 sc1
    s_add_u32 s69, s69, 55296
    s_waitcnt lgkmcnt(0)
    buffer_store_dwordx4 v[140:143], v233, s[40:43], s69 offen offset:2048 sc1
    s_barrier
    s_lshl_b32 s70, s60, 11
    s_lshl_b32 s71, s61, 7
    s_add_u32 s70, s70, s71
    s_add_u32 s70, s70, 0xe00000
    s_xor_b32 s71, s60, s66
    s_lshr_b32 s71, s71, 1
    s_lshl_b32 s71, s71, 30
    s_mov_b32 s60, s66
    s_and_b32 s52, s30, 1
    s_lshr_b32 s53, s30, 1
    s_lshl_b32 s68, s52, 1
    s_add_u32 s68, s68, s53
    v_and_b32 v238, 15, v0
    v_lshrrev_b32 v239, 4, v0
    v_mul_u32_u24 v240, 1280, v238
    v_lshl_add_u32 v240, v239, 4, v240
    s_lshl_b32 s54, s60, 1
    s_add_u32 s54, s54, s52
    s_mul_i32 s55, s54, 81920
    s_lshl_b32 s69, s63, 1
    s_add_u32 s69, s69, s53
    s_lshl_b32 s69, s69, 6
    s_add_u32 s55, s55, s69
    buffer_load_dwordx4 v[180:183], v240, s[32:35], s55 offen
    s_add_u32 s55, s55, 20480
    buffer_load_dwordx4 v[184:187], v240, s[32:35], s55 offen
    s_add_u32 s55, s55, 20480
    buffer_load_dwordx4 v[188:191], v240, s[32:35], s55 offen
    s_add_u32 s55, s55, 20480
    buffer_load_dwordx4 v[192:195], v240, s[32:35], s55 offen
    v_lshrrev_b32 v240, 2, v238
    v_lshl_add_u32 v240, v239, 2, v240
    v_bfe_u32 v241, v240, 1, 2
    v_lshlrev_b32 v240, 7, v240
    v_and_b32 v236, 3, v0
    v_lshl_add_u32 v240, v236, 3, v240
    s_lshl_b32 s54, s53, 12
    v_add_u32 v240, s54, v240
    v_xor_b32 v236, 0, v241
    v_lshl_add_u32 v220, v236, 5, v240
    v_add_u32 v224, 49152, v220
    v_add_u32 v228, 98304, v220
    v_xor_b32 v236, 1, v241
    v_lshl_add_u32 v221, v236, 5, v240
    v_add_u32 v225, 49152, v221
    v_add_u32 v229, 98304, v221
    v_xor_b32 v236, 2, v241
    v_lshl_add_u32 v222, v236, 5, v240
    v_add_u32 v226, 49152, v222
    v_add_u32 v230, 98304, v222
    v_xor_b32 v236, 3, v241
    v_lshl_add_u32 v223, v236, 5, v240
    v_add_u32 v227, 49152, v223
    v_add_u32 v231, 98304, v223
    v_lshlrev_b32 v236, 4, v0
    s_lshl_b32 s54, s53, 10
    v_add_u32 v232, s54, v236
    v_add_u32 v233, 55296, v232
    v_add_u32 v234, 110592, v232
    v_add_u32 v235, 165888, v232
    s_lshl_b32 s54, s60, 1
    s_add_u32 s54, s54, s52
    s_mul_i32 s57, s54, 221184
    s_mul_i32 s58, s65, 6144
    s_add_u32 s59, s57, s58
    v_lshlrev_b32 v240, 3, v239
    v_sub_u32 v240, v238, v240
    v_add_u32 v240, 0, v240
    v_and_b32 v241, 1, v240
    v_lshlrev_b32 v241, 4, v241
    v_mov_b32 v237, 0x3f80
    v_lshlrev_b32 v241, v241, v237
    v_lshrrev_b32 v240, 1, v240
    v_cmp_eq_u32 vcc, 0, v240
    s_nop 1
    v_cndmask_b32 v212, 0, v241, vcc
    v_cmp_eq_u32 vcc, 1, v240
    s_nop 1
    v_cndmask_b32 v213, 0, v241, vcc
    v_cmp_eq_u32 vcc, 2, v240
    s_nop 1
    v_cndmask_b32 v214, 0, v241, vcc
    v_cmp_eq_u32 vcc, 3, v240
    s_nop 1
    v_cndmask_b32 v215, 0, v241, vcc
    v_lshlrev_b32 v240, 3, v239
    v_sub_u32 v240, v238, v240
    v_add_u32 v240, 16, v240
    v_and_b32 v241, 1, v240
    v_lshlrev_b32 v241, 4, v241
    v_mov_b32 v237, 0x3f80
    v_lshlrev_b32 v241, v241, v237
    v_lshrrev_b32 v240, 1, v240
    v_cmp_eq_u32 vcc, 0, v240
    s_nop 1
    v_cndmask_b32 v216, 0, v241, vcc
    v_cmp_eq_u32 vcc, 1, v240
    s_nop 1
    v_cndmask_b32 v217, 0, v241, vcc
    v_cmp_eq_u32 vcc, 2, v240
    s_nop 1
    v_cndmask_b32 v218, 0, v241, vcc
    v_cmp_eq_u32 vcc, 3, v240
    s_nop 1
    v_cndmask_b32 v219, 0, v241, vcc
    v_lshlrev_b32 v237, 12, v238
    v_lshl_add_u32 v237, v239, 4, v237
    s_lshl_b32 s55, s60, 2
    s_add_u32 s55, s55, s68
    s_lshl_b32 s55, s55, 6
    s_lshl_b32 s69, s63, 18
    s_add_u32 s55, s55, s69
    s_add_u32 s55, s55, 0x710000
    v_mov_b32 v242, 159744
    v_mov_b32 v243, 1
    s_mov_b64 exec, 1
    s_waitcnt vmcnt(4)
    ds_add_rtn_u32 v243, v242, v243
    v_mov_b32 v242, s67
    v_bfrev_b32 v241, 2
    s_waitcnt lgkmcnt(0)
    v_cmp_eq_u32 vcc, 3, v243
    s_nop 1
    v_cndmask_b32 v243, v241, 0, vcc
    buffer_store_dword v242, v243, s[40:43], s70 offen sc1
    s_mov_b64 exec, -1
    s_cmp_ge_u32 s64, 20
    s_cbranch_scc1 k_wait
    s_barrier
    v_min_u32 v243, 10, v0
    v_lshlrev_b32 v243, 7, v243
    s_lshl_b32 s56, s60, 11
    s_add_u32 s56, s56, 0xe00000
    s_lshl_b32 s71, s30, 8
    s_add_u32 s71, s71, 160000
    v_lshl_add_u32 v242, v0, 2, s71
    ds_read_b32 v242, v242
    ds_read_b64_tr_b16 v[68:69], v224 offset:24576
    ds_read_b64_tr_b16 v[70:71], v224 offset:26624
    ds_read_b64_tr_b16 v[72:73], v225 offset:24576
    ds_read_b64_tr_b16 v[74:75], v225 offset:26624
    ds_read_b64_tr_b16 v[76:77], v226 offset:24576
    ds_read_b64_tr_b16 v[78:79], v226 offset:26624
    ds_read_b64_tr_b16 v[80:81], v227 offset:24576
    ds_read_b64_tr_b16 v[82:83], v227 offset:26624
    s_waitcnt vmcnt(1)
    s_cmp_lg_u32 s53, 0
    s_cbranch_scc1 g2_i1_13
    v_mfma_f32_16x16x32_bf16 v[4:7], v[212:215], v[180:183], 0
    v_mov_b32 v12, 0
    v_mov_b32 v13, 0
    v_mov_b32 v14, 0
    v_mov_b32 v15, 0
    v_mfma_f32_16x16x32_bf16 v[20:23], v[212:215], v[184:187], 0
    v_mov_b32 v28, 0
    v_mov_b32 v29, 0
    v_mov_b32 v30, 0
    v_mov_b32 v31, 0
    v_mfma_f32_16x16x32_bf16 v[36:39], v[212:215], v[188:191], 0
    v_mov_b32 v44, 0
    v_mov_b32 v45, 0
    v_mov_b32 v46, 0
    v_mov_b32 v47, 0
    v_mfma_f32_16x16x32_bf16 v[52:55], v[212:215], v[192:195], 0
    v_mov_b32 v60, 0
    v_mov_b32 v61, 0
    v_mov_b32 v62, 0
    v_mov_b32 v63, 0
    v_mfma_f32_16x16x32_bf16 v[8:11], v[216:219], v[180:183], 0
    v_mov_b32 v16, 0
    v_mov_b32 v17, 0
    v_mov_b32 v18, 0
    v_mov_b32 v19, 0
    v_mfma_f32_16x16x32_bf16 v[24:27], v[216:219], v[184:187], 0
    v_mov_b32 v32, 0
    v_mov_b32 v33, 0
    v_mov_b32 v34, 0
    v_mov_b32 v35, 0
    v_mfma_f32_16x16x32_bf16 v[40:43], v[216:219], v[188:191], 0
    v_mov_b32 v48, 0
    v_mov_b32 v49, 0
    v_mov_b32 v50, 0
    v_mov_b32 v51, 0
    v_mfma_f32_16x16x32_bf16 v[56:59], v[216:219], v[192:195], 0
    v_mov_b32 v64, 0
    v_mov_b32 v65, 0
    v_mov_b32 v66, 0
    v_mov_b32 v67, 0
    s_branch g2_id_14
g2_i1_13:
    v_mfma_f32_16x16x32_bf16 v[12:15], v[212:215], v[180:183], 0
    v_mov_b32 v4, 0
    v_mov_b32 v5, 0
    v_mov_b32 v6, 0
    v_mov_b32 v7, 0
    v_mfma_f32_16x16x32_bf16 v[28:31], v[212:215], v[184:187], 0
    v_mov_b32 v20, 0
    v_mov_b32 v21, 0
    v_mov_b32 v22, 0
    v_mov_b32 v23, 0
    v_mfma_f32_16x16x32_bf16 v[44:47], v[212:215], v[188:191], 0
    v_mov_b32 v36, 0
    v_mov_b32 v37, 0
    v_mov_b32 v38, 0
    v_mov_b32 v39, 0
    v_mfma_f32_16x16x32_bf16 v[60:63], v[212:215], v[192:195], 0
    v_mov_b32 v52, 0
    v_mov_b32 v53, 0
    v_mov_b32 v54, 0
    v_mov_b32 v55, 0
    v_mfma_f32_16x16x32_bf16 v[16:19], v[216:219], v[180:183], 0
    v_mov_b32 v8, 0
    v_mov_b32 v9, 0
    v_mov_b32 v10, 0
    v_mov_b32 v11, 0
    v_mfma_f32_16x16x32_bf16 v[32:35], v[216:219], v[184:187], 0
    v_mov_b32 v24, 0
    v_mov_b32 v25, 0
    v_mov_b32 v26, 0
    v_mov_b32 v27, 0
    v_mfma_f32_16x16x32_bf16 v[48:51], v[216:219], v[188:191], 0
    v_mov_b32 v40, 0
    v_mov_b32 v41, 0
    v_mov_b32 v42, 0
    v_mov_b32 v43, 0
    v_mfma_f32_16x16x32_bf16 v[64:67], v[216:219], v[192:195], 0
    v_mov_b32 v56, 0
    v_mov_b32 v57, 0
    v_mov_b32 v58, 0
    v_mov_b32 v59, 0
g2_id_14:
    s_waitcnt lgkmcnt(8)
    s_branch h_chk
h_poll:
    buffer_load_dword v242, v243, s[40:43], s56 offen sc1
h_chk:
    s_waitcnt vmcnt(0)
    v_cmp_ne_u32 vcc, s67, v242
    s_cbranch_vccnz h_poll
    buffer_load_dwordx4 v[100:103], v232, s[40:43], s59 offen sc1
    buffer_load_dwordx4 v[104:107], v233, s[40:43], s59 offen sc1
    buffer_load_dwordx4 v[108:111], v234, s[40:43], s59 offen sc1
    buffer_load_dwordx4 v[112:115], v235, s[40:43], s59 offen sc1
    s_add_u32 s58, s58, 2048
    s_add_u32 s59, s57, s58
    buffer_load_dwordx4 v[116:119], v232, s[40:43], s59 offen sc1
    buffer_load_dwordx4 v[120:123], v233, s[40:43], s59 offen sc1
    buffer_load_dwordx4 v[124:127], v234, s[40:43], s59 offen sc1
    buffer_load_dwordx4 v[128:131], v235, s[40:43], s59 offen sc1
    s_add_u32 s58, s58, 2048
    s_add_u32 s59, s57, s58
    buffer_load_dwordx4 v[132:135], v232, s[40:43], s59 offen sc1
    buffer_load_dwordx4 v[136:139], v233, s[40:43], s59 offen sc1
    buffer_load_dwordx4 v[140:143], v234, s[40:43], s59 offen sc1
    buffer_load_dwordx4 v[144:147], v235, s[40:43], s59 offen sc1
    s_add_u32 s58, s58, 2048
    s_cmp_eq_u32 s58, 55296
    s_cselect_b32 s58, 0, s58
    s_add_u32 s59, s57, s58
    buffer_load_dwordx4 v[148:151], v232, s[40:43], s59 offen sc1
    buffer_load_dwordx4 v[152:155], v233, s[40:43], s59 offen sc1
    buffer_load_dwordx4 v[156:159], v234, s[40:43], s59 offen sc1
    buffer_load_dwordx4 v[160:163], v235, s[40:43], s59 offen sc1
    s_waitcnt lgkmcnt(0)
    s_waitcnt vmcnt(15)
    v_mfma_f32_16x16x32_bf16 v[4:7], v[68:71], v[100:103], v[4:7]
    ds_read_b64_tr_b16 v[84:85], v224 offset:32768
    s_waitcnt vmcnt(14)
    v_mfma_f32_16x16x32_bf16 v[20:23], v[68:71], v[104:107], v[20:23]
    ds_read_b64_tr_b16 v[86:87], v224 offset:34816
    s_waitcnt vmcnt(13)
    v_mfma_f32_16x16x32_bf16 v[36:39], v[68:71], v[108:111], v[36:39]
    ds_read_b64_tr_b16 v[88:89], v225 offset:32768
    s_waitcnt vmcnt(12)
    v_mfma_f32_16x16x32_bf16 v[52:55], v[68:71], v[112:115], v[52:55]
    ds_read_b64_tr_b16 v[90:91], v225 offset:34816
    v_mfma_f32_16x16x32_bf16 v[8:11], v[72:75], v[100:103], v[8:11]
    ds_read_b64_tr_b16 v[92:93], v226 offset:32768
    v_mfma_f32_16x16x32_bf16 v[24:27], v[72:75], v[104:107], v[24:27]
    ds_read_b64_tr_b16 v[94:95], v226 offset:34816
    v_mfma_f32_16x16x32_bf16 v[40:43], v[72:75], v[108:111], v[40:43]
    ds_read_b64_tr_b16 v[96:97], v227 offset:32768
    v_mfma_f32_16x16x32_bf16 v[56:59], v[72:75], v[112:115], v[56:59]
    ds_read_b64_tr_b16 v[98:99], v227 offset:34816
    v_mfma_f32_16x16x32_bf16 v[12:15], v[76:79], v[100:103], v[12:15]
    s_add_u32 s58, s58, 2048
    s_add_u32 s59, s57, s58
    v_mfma_f32_16x16x32_bf16 v[28:31], v[76:79], v[104:107], v[28:31]
    buffer_load_dwordx4 v[164:167], v232, s[40:43], s59 offen sc1
    v_mfma_f32_16x16x32_bf16 v[44:47], v[76:79], v[108:111], v[44:47]
    buffer_load_dwordx4 v[168:171], v233, s[40:43], s59 offen sc1
    v_mfma_f32_16x16x32_bf16 v[60:63], v[76:79], v[112:115], v[60:63]
    buffer_load_dwordx4 v[172:175], v234, s[40:43], s59 offen sc1
    v_mfma_f32_16x16x32_bf16 v[16:19], v[80:83], v[100:103], v[16:19]
    buffer_load_dwordx4 v[176:179], v235, s[40:43], s59 offen sc1
    v_mfma_f32_16x16x32_bf16 v[32:35], v[80:83], v[104:107], v[32:35]
    s_add_u32 s58, s58, 2048
    s_add_u32 s59, s57, s58
    v_mfma_f32_16x16x32_bf16 v[48:51], v[80:83], v[108:111], v[48:51]
    buffer_load_dwordx4 v[180:183], v232, s[40:43], s59 offen sc1
    v_mfma_f32_16x16x32_bf16 v[64:67], v[80:83], v[112:115], v[64:67]
    buffer_load_dwordx4 v[184:187], v233, s[40:43], s59 offen sc1
    buffer_load_dwordx4 v[188:191], v234, s[40:43], s59 offen sc1
    buffer_load_dwordx4 v[192:195], v235, s[40:43], s59 offen sc1
    s_waitcnt lgkmcnt(0)
    s_waitcnt vmcnt(19)
    v_mfma_f32_16x16x32_bf16 v[4:7], v[84:87], v[116:119], v[4:7]
    ds_read_b64_tr_b16 v[68:69], v224 offset:40960
    s_waitcnt vmcnt(18)
    v_mfma_f32_16x16x32_bf16 v[20:23], v[84:87], v[120:123], v[20:23]
    ds_read_b64_tr_b16 v[70:71], v224 offset:43008
    s_waitcnt vmcnt(17)
    v_mfma_f32_16x16x32_bf16 v[36:39], v[84:87], v[124:127], v[36:39]
    ds_read_b64_tr_b16 v[72:73], v225 offset:40960
    s_waitcnt vmcnt(16)
    v_mfma_f32_16x16x32_bf16 v[52:55], v[84:87], v[128:131], v[52:55]
    ds_read_b64_tr_b16 v[74:75], v225 offset:43008
    v_mfma_f32_16x16x32_bf16 v[8:11], v[88:91], v[116:119], v[8:11]
    ds_read_b64_tr_b16 v[76:77], v226 offset:40960
    v_mfma_f32_16x16x32_bf16 v[24:27], v[88:91], v[120:123], v[24:27]
    ds_read_b64_tr_b16 v[78:79], v226 offset:43008
    v_mfma_f32_16x16x32_bf16 v[40:43], v[88:91], v[124:127], v[40:43]
    ds_read_b64_tr_b16 v[80:81], v227 offset:40960
    v_mfma_f32_16x16x32_bf16 v[56:59], v[88:91], v[128:131], v[56:59]
    ds_read_b64_tr_b16 v[82:83], v227 offset:43008
    v_mfma_f32_16x16x32_bf16 v[12:15], v[92:95], v[116:119], v[12:15]
    s_add_u32 s58, s58, 2048
    s_cmp_eq_u32 s58, 55296
    v_mfma_f32_16x16x32_bf16 v[28:31], v[92:95], v[120:123], v[28:31]
    s_cselect_b32 s58, 0, s58
    s_add_u32 s59, s57, s58
    v_mfma_f32_16x16x32_bf16 v[44:47], v[92:95], v[124:127], v[44:47]
    buffer_load_dwordx4 v[100:103], v232, s[40:43], s59 offen sc1
    v_mfma_f32_16x16x32_bf16 v[60:63], v[92:95], v[128:131], v[60:63]
    buffer_load_dwordx4 v[104:107], v233, s[40:43], s59 offen sc1
    v_mfma_f32_16x16x32_bf16 v[16:19], v[96:99], v[116:119], v[16:19]
    buffer_load_dwordx4 v[108:111], v234, s[40:43], s59 offen sc1
    v_mfma_f32_16x16x32_bf16 v[32:35], v[96:99], v[120:123], v[32:35]
    buffer_load_dwordx4 v[112:115], v235, s[40:43], s59 offen sc1
    v_mfma_f32_16x16x32_bf16 v[48:51], v[96:99], v[124:127], v[48:51]
    v_mfma_f32_16x16x32_bf16 v[64:67], v[96:99], v[128:131], v[64:67]
    s_waitcnt lgkmcnt(0)
    s_barrier
    s_waitcnt vmcnt(19)
    v_mfma_f32_16x16x32_bf16 v[4:7], v[68:71], v[132:135], v[4:7]
    ds_read_b64_tr_b16 v[84:85], v228 offset:0
    s_waitcnt vmcnt(18)
    v_mfma_f32_16x16x32_bf16 v[20:23], v[68:71], v[136:139], v[20:23]
    ds_read_b64_tr_b16 v[86:87], v228 offset:2048
    s_waitcnt vmcnt(17)
    v_mfma_f32_16x16x32_bf16 v[36:39], v[68:71], v[140:143], v[36:39]
    ds_read_b64_tr_b16 v[88:89], v229 offset:0
    s_waitcnt vmcnt(16)
    v_mfma_f32_16x16x32_bf16 v[52:55], v[68:71], v[144:147], v[52:55]
    ds_read_b64_tr_b16 v[90:91], v229 offset:2048
    v_mfma_f32_16x16x32_bf16 v[8:11], v[72:75], v[132:135], v[8:11]
    ds_read_b64_tr_b16 v[92:93], v230 offset:0
    v_mfma_f32_16x16x32_bf16 v[24:27], v[72:75], v[136:139], v[24:27]
    ds_read_b64_tr_b16 v[94:95], v230 offset:2048
    v_mfma_f32_16x16x32_bf16 v[40:43], v[72:75], v[140:143], v[40:43]
    ds_read_b64_tr_b16 v[96:97], v231 offset:0
    v_mfma_f32_16x16x32_bf16 v[56:59], v[72:75], v[144:147], v[56:59]
    ds_read_b64_tr_b16 v[98:99], v231 offset:2048
    v_mfma_f32_16x16x32_bf16 v[12:15], v[76:79], v[132:135], v[12:15]
    s_add_u32 s58, s58, 2048
    s_add_u32 s59, s57, s58
    v_mfma_f32_16x16x32_bf16 v[28:31], v[76:79], v[136:139], v[28:31]
    buffer_load_dwordx4 v[116:119], v232, s[40:43], s59 offen sc1
    v_mfma_f32_16x16x32_bf16 v[44:47], v[76:79], v[140:143], v[44:47]
    buffer_load_dwordx4 v[120:123], v233, s[40:43], s59 offen sc1
    v_mfma_f32_16x16x32_bf16 v[60:63], v[76:79], v[144:147], v[60:63]
    buffer_load_dwordx4 v[124:127], v234, s[40:43], s59 offen sc1
    v_mfma_f32_16x16x32_bf16 v[16:19], v[80:83], v[132:135], v[16:19]
    buffer_load_dwordx4 v[128:131], v235, s[40:43], s59 offen sc1
    v_mfma_f32_16x16x32_bf16 v[32:35], v[80:83], v[136:139], v[32:35]
    v_mfma_f32_16x16x32_bf16 v[48:51], v[80:83], v[140:143], v[48:51]
    v_mfma_f32_16x16x32_bf16 v[64:67], v[80:83], v[144:147], v[64:67]
    s_waitcnt lgkmcnt(0)
    s_waitcnt vmcnt(19)
    v_mfma_f32_16x16x32_bf16 v[4:7], v[84:87], v[148:151], v[4:7]
    ds_read_b64_tr_b16 v[68:69], v228 offset:8192
    s_waitcnt vmcnt(18)
    v_mfma_f32_16x16x32_bf16 v[20:23], v[84:87], v[152:155], v[20:23]
    ds_read_b64_tr_b16 v[70:71], v228 offset:10240
    s_waitcnt vmcnt(17)
    v_mfma_f32_16x16x32_bf16 v[36:39], v[84:87], v[156:159], v[36:39]
    ds_read_b64_tr_b16 v[72:73], v229 offset:8192
    s_waitcnt vmcnt(16)
    v_mfma_f32_16x16x32_bf16 v[52:55], v[84:87], v[160:163], v[52:55]
    ds_read_b64_tr_b16 v[74:75], v229 offset:10240
    v_mfma_f32_16x16x32_bf16 v[8:11], v[88:91], v[148:151], v[8:11]
    ds_read_b64_tr_b16 v[76:77], v230 offset:8192
    v_mfma_f32_16x16x32_bf16 v[24:27], v[88:91], v[152:155], v[24:27]
    ds_read_b64_tr_b16 v[78:79], v230 offset:10240
    v_mfma_f32_16x16x32_bf16 v[40:43], v[88:91], v[156:159], v[40:43]
    ds_read_b64_tr_b16 v[80:81], v231 offset:8192
    v_mfma_f32_16x16x32_bf16 v[56:59], v[88:91], v[160:163], v[56:59]
    ds_read_b64_tr_b16 v[82:83], v231 offset:10240
    v_mfma_f32_16x16x32_bf16 v[12:15], v[92:95], v[148:151], v[12:15]
    s_add_u32 s58, s58, 2048
    s_add_u32 s59, s57, s58
    v_mfma_f32_16x16x32_bf16 v[28:31], v[92:95], v[152:155], v[28:31]
    buffer_load_dwordx4 v[132:135], v232, s[40:43], s59 offen sc1
    v_mfma_f32_16x16x32_bf16 v[44:47], v[92:95], v[156:159], v[44:47]
    buffer_load_dwordx4 v[136:139], v233, s[40:43], s59 offen sc1
    v_mfma_f32_16x16x32_bf16 v[60:63], v[92:95], v[160:163], v[60:63]
    buffer_load_dwordx4 v[140:143], v234, s[40:43], s59 offen sc1
    v_mfma_f32_16x16x32_bf16 v[16:19], v[96:99], v[148:151], v[16:19]
    buffer_load_dwordx4 v[144:147], v235, s[40:43], s59 offen sc1
    v_mfma_f32_16x16x32_bf16 v[32:35], v[96:99], v[152:155], v[32:35]
    v_mfma_f32_16x16x32_bf16 v[48:51], v[96:99], v[156:159], v[48:51]
    v_mfma_f32_16x16x32_bf16 v[64:67], v[96:99], v[160:163], v[64:67]
    s_waitcnt lgkmcnt(0)
    s_waitcnt vmcnt(19)
    v_mfma_f32_16x16x32_bf16 v[4:7], v[68:71], v[164:167], v[4:7]
    ds_read_b64_tr_b16 v[84:85], v228 offset:16384
    s_waitcnt vmcnt(18)
    v_mfma_f32_16x16x32_bf16 v[20:23], v[68:71], v[168:171], v[20:23]
    ds_read_b64_tr_b16 v[86:87], v228 offset:18432
    s_waitcnt vmcnt(17)
    v_mfma_f32_16x16x32_bf16 v[36:39], v[68:71], v[172:175], v[36:39]
    ds_read_b64_tr_b16 v[88:89], v229 offset:16384
    s_waitcnt vmcnt(16)
    v_mfma_f32_16x16x32_bf16 v[52:55], v[68:71], v[176:179], v[52:55]
    ds_read_b64_tr_b16 v[90:91], v229 offset:18432
    v_mfma_f32_16x16x32_bf16 v[8:11], v[72:75], v[164:167], v[8:11]
    ds_read_b64_tr_b16 v[92:93], v230 offset:16384
    v_mfma_f32_16x16x32_bf16 v[24:27], v[72:75], v[168:171], v[24:27]
    ds_read_b64_tr_b16 v[94:95], v230 offset:18432
    v_mfma_f32_16x16x32_bf16 v[40:43], v[72:75], v[172:175], v[40:43]
    ds_read_b64_tr_b16 v[96:97], v231 offset:16384
    v_mfma_f32_16x16x32_bf16 v[56:59], v[72:75], v[176:179], v[56:59]
    ds_read_b64_tr_b16 v[98:99], v231 offset:18432
    v_mfma_f32_16x16x32_bf16 v[12:15], v[76:79], v[164:167], v[12:15]
    s_add_u32 s58, s58, 2048
    s_cmp_eq_u32 s58, 55296
    v_mfma_f32_16x16x32_bf16 v[28:31], v[76:79], v[168:171], v[28:31]
    s_cselect_b32 s58, 0, s58
    s_add_u32 s59, s57, s58
    v_mfma_f32_16x16x32_bf16 v[44:47], v[76:79], v[172:175], v[44:47]
    buffer_load_dwordx4 v[148:151], v232, s[40:43], s59 offen sc1
    v_mfma_f32_16x16x32_bf16 v[60:63], v[76:79], v[176:179], v[60:63]
    buffer_load_dwordx4 v[152:155], v233, s[40:43], s59 offen sc1
    v_mfma_f32_16x16x32_bf16 v[16:19], v[80:83], v[164:167], v[16:19]
    buffer_load_dwordx4 v[156:159], v234, s[40:43], s59 offen sc1
    v_mfma_f32_16x16x32_bf16 v[32:35], v[80:83], v[168:171], v[32:35]
    buffer_load_dwordx4 v[160:163], v235, s[40:43], s59 offen sc1
    v_mfma_f32_16x16x32_bf16 v[48:51], v[80:83], v[172:175], v[48:51]
    v_mfma_f32_16x16x32_bf16 v[64:67], v[80:83], v[176:179], v[64:67]
    s_waitcnt lgkmcnt(0)
    s_barrier
    s_waitcnt vmcnt(19)
    v_mfma_f32_16x16x32_bf16 v[4:7], v[84:87], v[180:183], v[4:7]
    ds_read_b64_tr_b16 v[68:69], v228 offset:24576
    s_waitcnt vmcnt(18)
    v_mfma_f32_16x16x32_bf16 v[20:23], v[84:87], v[184:187], v[20:23]
    ds_read_b64_tr_b16 v[70:71], v228 offset:26624
    s_waitcnt vmcnt(17)
    v_mfma_f32_16x16x32_bf16 v[36:39], v[84:87], v[188:191], v[36:39]
    ds_read_b64_tr_b16 v[72:73], v229 offset:24576
    s_waitcnt vmcnt(16)
    v_mfma_f32_16x16x32_bf16 v[52:55], v[84:87], v[192:195], v[52:55]
    ds_read_b64_tr_b16 v[74:75], v229 offset:26624
    v_mfma_f32_16x16x32_bf16 v[8:11], v[88:91], v[180:183], v[8:11]
    ds_read_b64_tr_b16 v[76:77], v230 offset:24576
    v_mfma_f32_16x16x32_bf16 v[24:27], v[88:91], v[184:187], v[24:27]
    ds_read_b64_tr_b16 v[78:79], v230 offset:26624
    v_mfma_f32_16x16x32_bf16 v[40:43], v[88:91], v[188:191], v[40:43]
    ds_read_b64_tr_b16 v[80:81], v231 offset:24576
    v_mfma_f32_16x16x32_bf16 v[56:59], v[88:91], v[192:195], v[56:59]
    ds_read_b64_tr_b16 v[82:83], v231 offset:26624
    v_mfma_f32_16x16x32_bf16 v[12:15], v[92:95], v[180:183], v[12:15]
    s_add_u32 s58, s58, 2048
    s_add_u32 s59, s57, s58
    v_mfma_f32_16x16x32_bf16 v[28:31], v[92:95], v[184:187], v[28:31]
    buffer_load_dwordx4 v[164:167], v232, s[40:43], s59 offen sc1
    v_mfma_f32_16x16x32_bf16 v[44:47], v[92:95], v[188:191], v[44:47]
    buffer_load_dwordx4 v[168:171], v233, s[40:43], s59 offen sc1
    v_mfma_f32_16x16x32_bf16 v[60:63], v[92:95], v[192:195], v[60:63]
    buffer_load_dwordx4 v[172:175], v234, s[40:43], s59 offen sc1
    v_mfma_f32_16x16x32_bf16 v[16:19], v[96:99], v[180:183], v[16:19]
    buffer_load_dwordx4 v[176:179], v235, s[40:43], s59 offen sc1
    v_mfma_f32_16x16x32_bf16 v[32:35], v[96:99], v[184:187], v[32:35]
    v_mfma_f32_16x16x32_bf16 v[48:51], v[96:99], v[188:191], v[48:51]
    v_mfma_f32_16x16x32_bf16 v[64:67], v[96:99], v[192:195], v[64:67]
    s_waitcnt lgkmcnt(0)
    s_waitcnt vmcnt(19)
    v_mfma_f32_16x16x32_bf16 v[4:7], v[68:71], v[100:103], v[4:7]
    ds_read_b64_tr_b16 v[84:85], v228 offset:32768
    s_waitcnt vmcnt(18)
    v_mfma_f32_16x16x32_bf16 v[20:23], v[68:71], v[104:107], v[20:23]
    ds_read_b64_tr_b16 v[86:87], v228 offset:34816
    s_waitcnt vmcnt(17)
    v_mfma_f32_16x16x32_bf16 v[36:39], v[68:71], v[108:111], v[36:39]
    ds_read_b64_tr_b16 v[88:89], v229 offset:32768
    s_waitcnt vmcnt(16)
    v_mfma_f32_16x16x32_bf16 v[52:55], v[68:71], v[112:115], v[52:55]
    ds_read_b64_tr_b16 v[90:91], v229 offset:34816
    v_mfma_f32_16x16x32_bf16 v[8:11], v[72:75], v[100:103], v[8:11]
    ds_read_b64_tr_b16 v[92:93], v230 offset:32768
    v_mfma_f32_16x16x32_bf16 v[24:27], v[72:75], v[104:107], v[24:27]
    ds_read_b64_tr_b16 v[94:95], v230 offset:34816
    v_mfma_f32_16x16x32_bf16 v[40:43], v[72:75], v[108:111], v[40:43]
    ds_read_b64_tr_b16 v[96:97], v231 offset:32768
    v_mfma_f32_16x16x32_bf16 v[56:59], v[72:75], v[112:115], v[56:59]
    ds_read_b64_tr_b16 v[98:99], v231 offset:34816
    v_mfma_f32_16x16x32_bf16 v[12:15], v[76:79], v[100:103], v[12:15]
    s_add_u32 s58, s58, 2048
    s_add_u32 s59, s57, s58
    v_mfma_f32_16x16x32_bf16 v[28:31], v[76:79], v[104:107], v[28:31]
    buffer_load_dwordx4 v[180:183], v232, s[40:43], s59 offen sc1
    v_mfma_f32_16x16x32_bf16 v[44:47], v[76:79], v[108:111], v[44:47]
    buffer_load_dwordx4 v[184:187], v233, s[40:43], s59 offen sc1
    v_mfma_f32_16x16x32_bf16 v[60:63], v[76:79], v[112:115], v[60:63]
    buffer_load_dwordx4 v[188:191], v234, s[40:43], s59 offen sc1
    v_mfma_f32_16x16x32_bf16 v[16:19], v[80:83], v[100:103], v[16:19]
    buffer_load_dwordx4 v[192:195], v235, s[40:43], s59 offen sc1
    v_mfma_f32_16x16x32_bf16 v[32:35], v[80:83], v[104:107], v[32:35]
    v_mfma_f32_16x16x32_bf16 v[48:51], v[80:83], v[108:111], v[48:51]
    v_mfma_f32_16x16x32_bf16 v[64:67], v[80:83], v[112:115], v[64:67]
    s_waitcnt lgkmcnt(0)
    s_waitcnt vmcnt(19)
    v_mfma_f32_16x16x32_bf16 v[4:7], v[84:87], v[116:119], v[4:7]
    ds_read_b64_tr_b16 v[68:69], v228 offset:40960
    s_waitcnt vmcnt(18)
    v_mfma_f32_16x16x32_bf16 v[20:23], v[84:87], v[120:123], v[20:23]
    ds_read_b64_tr_b16 v[70:71], v228 offset:43008
    s_waitcnt vmcnt(17)
    v_mfma_f32_16x16x32_bf16 v[36:39], v[84:87], v[124:127], v[36:39]
    ds_read_b64_tr_b16 v[72:73], v229 offset:40960
    s_waitcnt vmcnt(16)
    v_mfma_f32_16x16x32_bf16 v[52:55], v[84:87], v[128:131], v[52:55]
    ds_read_b64_tr_b16 v[74:75], v229 offset:43008
    v_mfma_f32_16x16x32_bf16 v[8:11], v[88:91], v[116:119], v[8:11]
    ds_read_b64_tr_b16 v[76:77], v230 offset:40960
    v_mfma_f32_16x16x32_bf16 v[24:27], v[88:91], v[120:123], v[24:27]
    ds_read_b64_tr_b16 v[78:79], v230 offset:43008
    v_mfma_f32_16x16x32_bf16 v[40:43], v[88:91], v[124:127], v[40:43]
    ds_read_b64_tr_b16 v[80:81], v231 offset:40960
    v_mfma_f32_16x16x32_bf16 v[56:59], v[88:91], v[128:131], v[56:59]
    ds_read_b64_tr_b16 v[82:83], v231 offset:43008
    v_mfma_f32_16x16x32_bf16 v[12:15], v[92:95], v[116:119], v[12:15]
    s_add_u32 s58, s58, 2048
    s_cmp_eq_u32 s58, 55296
    v_mfma_f32_16x16x32_bf16 v[28:31], v[92:95], v[120:123], v[28:31]
    s_cselect_b32 s58, 0, s58
    s_add_u32 s59, s57, s58
    v_mfma_f32_16x16x32_bf16 v[44:47], v[92:95], v[124:127], v[44:47]
    buffer_load_dwordx4 v[100:103], v232, s[40:43], s59 offen sc1
    v_mfma_f32_16x16x32_bf16 v[60:63], v[92:95], v[128:131], v[60:63]
    buffer_load_dwordx4 v[104:107], v233, s[40:43], s59 offen sc1
    v_mfma_f32_16x16x32_bf16 v[16:19], v[96:99], v[116:119], v[16:19]
    buffer_load_dwordx4 v[108:111], v234, s[40:43], s59 offen sc1
    v_mfma_f32_16x16x32_bf16 v[32:35], v[96:99], v[120:123], v[32:35]
    buffer_load_dwordx4 v[112:115], v235, s[40:43], s59 offen sc1
    v_mfma_f32_16x16x32_bf16 v[48:51], v[96:99], v[124:127], v[48:51]
    v_mfma_f32_16x16x32_bf16 v[64:67], v[96:99], v[128:131], v[64:67]
    s_waitcnt lgkmcnt(0)
    s_barrier
    s_waitcnt vmcnt(19)
    v_mfma_f32_16x16x32_bf16 v[4:7], v[68:71], v[132:135], v[4:7]
    ds_read_b64_tr_b16 v[84:85], v220 offset:0
    s_waitcnt vmcnt(18)
    v_mfma_f32_16x16x32_bf16 v[20:23], v[68:71], v[136:139], v[20:23]
    ds_read_b64_tr_b16 v[86:87], v220 offset:2048
    s_waitcnt vmcnt(17)
    v_mfma_f32_16x16x32_bf16 v[36:39], v[68:71], v[140:143], v[36:39]
    ds_read_b64_tr_b16 v[88:89], v221 offset:0
    s_waitcnt vmcnt(16)
    v_mfma_f32_16x16x32_bf16 v[52:55], v[68:71], v[144:147], v[52:55]
    ds_read_b64_tr_b16 v[90:91], v221 offset:2048
    v_mfma_f32_16x16x32_bf16 v[8:11], v[72:75], v[132:135], v[8:11]
    ds_read_b64_tr_b16 v[92:93], v222 offset:0
    v_mfma_f32_16x16x32_bf16 v[24:27], v[72:75], v[136:139], v[24:27]
    ds_read_b64_tr_b16 v[94:95], v222 offset:2048
    v_mfma_f32_16x16x32_bf16 v[40:43], v[72:75], v[140:143], v[40:43]
    ds_read_b64_tr_b16 v[96:97], v223 offset:0
    v_mfma_f32_16x16x32_bf16 v[56:59], v[72:75], v[144:147], v[56:59]
    ds_read_b64_tr_b16 v[98:99], v223 offset:2048
    v_mfma_f32_16x16x32_bf16 v[12:15], v[76:79], v[132:135], v[12:15]
    s_add_u32 s58, s58, 2048
    s_add_u32 s59, s57, s58
    v_mfma_f32_16x16x32_bf16 v[28:31], v[76:79], v[136:139], v[28:31]
    buffer_load_dwordx4 v[116:119], v232, s[40:43], s59 offen sc1
    v_mfma_f32_16x16x32_bf16 v[44:47], v[76:79], v[140:143], v[44:47]
    buffer_load_dwordx4 v[120:123], v233, s[40:43], s59 offen sc1
    v_mfma_f32_16x16x32_bf16 v[60:63], v[76:79], v[144:147], v[60:63]
    buffer_load_dwordx4 v[124:127], v234, s[40:43], s59 offen sc1
    v_mfma_f32_16x16x32_bf16 v[16:19], v[80:83], v[132:135], v[16:19]
    buffer_load_dwordx4 v[128:131], v235, s[40:43], s59 offen sc1
    v_mfma_f32_16x16x32_bf16 v[32:35], v[80:83], v[136:139], v[32:35]
    v_mfma_f32_16x16x32_bf16 v[48:51], v[80:83], v[140:143], v[48:51]
    v_mfma_f32_16x16x32_bf16 v[64:67], v[80:83], v[144:147], v[64:67]
    s_waitcnt lgkmcnt(0)
    s_waitcnt vmcnt(19)
    v_mfma_f32_16x16x32_bf16 v[4:7], v[84:87], v[148:151], v[4:7]
    ds_read_b64_tr_b16 v[68:69], v220 offset:8192
    s_waitcnt vmcnt(18)
    v_mfma_f32_16x16x32_bf16 v[20:23], v[84:87], v[152:155], v[20:23]
    ds_read_b64_tr_b16 v[70:71], v220 offset:10240
    s_waitcnt vmcnt(17)
    v_mfma_f32_16x16x32_bf16 v[36:39], v[84:87], v[156:159], v[36:39]
    ds_read_b64_tr_b16 v[72:73], v221 offset:8192
    s_waitcnt vmcnt(16)
    v_mfma_f32_16x16x32_bf16 v[52:55], v[84:87], v[160:163], v[52:55]
    ds_read_b64_tr_b16 v[74:75], v221 offset:10240
    v_mfma_f32_16x16x32_bf16 v[8:11], v[88:91], v[148:151], v[8:11]
    ds_read_b64_tr_b16 v[76:77], v222 offset:8192
    v_mfma_f32_16x16x32_bf16 v[24:27], v[88:91], v[152:155], v[24:27]
    ds_read_b64_tr_b16 v[78:79], v222 offset:10240
    v_mfma_f32_16x16x32_bf16 v[40:43], v[88:91], v[156:159], v[40:43]
    ds_read_b64_tr_b16 v[80:81], v223 offset:8192
    v_mfma_f32_16x16x32_bf16 v[56:59], v[88:91], v[160:163], v[56:59]
    ds_read_b64_tr_b16 v[82:83], v223 offset:10240
    v_mfma_f32_16x16x32_bf16 v[12:15], v[92:95], v[148:151], v[12:15]
    s_add_u32 s58, s58, 2048
    s_add_u32 s59, s57, s58
    v_mfma_f32_16x16x32_bf16 v[28:31], v[92:95], v[152:155], v[28:31]
    buffer_load_dwordx4 v[132:135], v232, s[40:43], s59 offen sc1
    v_mfma_f32_16x16x32_bf16 v[44:47], v[92:95], v[156:159], v[44:47]
    buffer_load_dwordx4 v[136:139], v233, s[40:43], s59 offen sc1
    v_mfma_f32_16x16x32_bf16 v[60:63], v[92:95], v[160:163], v[60:63]
    buffer_load_dwordx4 v[140:143], v234, s[40:43], s59 offen sc1
    v_mfma_f32_16x16x32_bf16 v[16:19], v[96:99], v[148:151], v[16:19]
    buffer_load_dwordx4 v[144:147], v235, s[40:43], s59 offen sc1
    v_mfma_f32_16x16x32_bf16 v[32:35], v[96:99], v[152:155], v[32:35]
    v_mfma_f32_16x16x32_bf16 v[48:51], v[96:99], v[156:159], v[48:51]
    v_mfma_f32_16x16x32_bf16 v[64:67], v[96:99], v[160:163], v[64:67]
    s_waitcnt lgkmcnt(0)
    s_waitcnt vmcnt(19)
    v_mfma_f32_16x16x32_bf16 v[4:7], v[68:71], v[164:167], v[4:7]
    ds_read_b64_tr_b16 v[84:85], v220 offset:16384
    s_waitcnt vmcnt(18)
    v_mfma_f32_16x16x32_bf16 v[20:23], v[68:71], v[168:171], v[20:23]
    ds_read_b64_tr_b16 v[86:87], v220 offset:18432
    s_waitcnt vmcnt(17)
    v_mfma_f32_16x16x32_bf16 v[36:39], v[68:71], v[172:175], v[36:39]
    ds_read_b64_tr_b16 v[88:89], v221 offset:16384
    s_waitcnt vmcnt(16)
    v_mfma_f32_16x16x32_bf16 v[52:55], v[68:71], v[176:179], v[52:55]
    ds_read_b64_tr_b16 v[90:91], v221 offset:18432
    v_mfma_f32_16x16x32_bf16 v[8:11], v[72:75], v[164:167], v[8:11]
    ds_read_b64_tr_b16 v[92:93], v222 offset:16384
    v_mfma_f32_16x16x32_bf16 v[24:27], v[72:75], v[168:171], v[24:27]
    ds_read_b64_tr_b16 v[94:95], v222 offset:18432
    v_mfma_f32_16x16x32_bf16 v[40:43], v[72:75], v[172:175], v[40:43]
    ds_read_b64_tr_b16 v[96:97], v223 offset:16384
    v_mfma_f32_16x16x32_bf16 v[56:59], v[72:75], v[176:179], v[56:59]
    ds_read_b64_tr_b16 v[98:99], v223 offset:18432
    v_mfma_f32_16x16x32_bf16 v[12:15], v[76:79], v[164:167], v[12:15]
    s_add_u32 s58, s58, 2048
    s_cmp_eq_u32 s58, 55296
    v_mfma_f32_16x16x32_bf16 v[28:31], v[76:79], v[168:171], v[28:31]
    s_cselect_b32 s58, 0, s58
    s_add_u32 s59, s57, s58
    v_mfma_f32_16x16x32_bf16 v[44:47], v[76:79], v[172:175], v[44:47]
    buffer_load_dwordx4 v[148:151], v232, s[40:43], s59 offen sc1
    v_mfma_f32_16x16x32_bf16 v[60:63], v[76:79], v[176:179], v[60:63]
    buffer_load_dwordx4 v[152:155], v233, s[40:43], s59 offen sc1
    v_mfma_f32_16x16x32_bf16 v[16:19], v[80:83], v[164:167], v[16:19]
    buffer_load_dwordx4 v[156:159], v234, s[40:43], s59 offen sc1
    v_mfma_f32_16x16x32_bf16 v[32:35], v[80:83], v[168:171], v[32:35]
    buffer_load_dwordx4 v[160:163], v235, s[40:43], s59 offen sc1
    v_mfma_f32_16x16x32_bf16 v[48:51], v[80:83], v[172:175], v[48:51]
    v_mfma_f32_16x16x32_bf16 v[64:67], v[80:83], v[176:179], v[64:67]
    s_waitcnt lgkmcnt(0)
    s_barrier
    s_waitcnt vmcnt(19)
    v_mfma_f32_16x16x32_bf16 v[4:7], v[84:87], v[180:183], v[4:7]
    ds_read_b64_tr_b16 v[68:69], v220 offset:24576
    s_waitcnt vmcnt(18)
    v_mfma_f32_16x16x32_bf16 v[20:23], v[84:87], v[184:187], v[20:23]
    ds_read_b64_tr_b16 v[70:71], v220 offset:26624
    s_waitcnt vmcnt(17)
    v_mfma_f32_16x16x32_bf16 v[36:39], v[84:87], v[188:191], v[36:39]
    ds_read_b64_tr_b16 v[72:73], v221 offset:24576
    s_waitcnt vmcnt(16)
    v_mfma_f32_16x16x32_bf16 v[52:55], v[84:87], v[192:195], v[52:55]
    ds_read_b64_tr_b16 v[74:75], v221 offset:26624
    v_mfma_f32_16x16x32_bf16 v[8:11], v[88:91], v[180:183], v[8:11]
    ds_read_b64_tr_b16 v[76:77], v222 offset:24576
    v_mfma_f32_16x16x32_bf16 v[24:27], v[88:91], v[184:187], v[24:27]
    ds_read_b64_tr_b16 v[78:79], v222 offset:26624
    v_mfma_f32_16x16x32_bf16 v[40:43], v[88:91], v[188:191], v[40:43]
    ds_read_b64_tr_b16 v[80:81], v223 offset:24576
    v_mfma_f32_16x16x32_bf16 v[56:59], v[88:91], v[192:195], v[56:59]
    ds_read_b64_tr_b16 v[82:83], v223 offset:26624
    v_mfma_f32_16x16x32_bf16 v[12:15], v[92:95], v[180:183], v[12:15]
    s_add_u32 s58, s58, 2048
    s_add_u32 s59, s57, s58
    v_mfma_f32_16x16x32_bf16 v[28:31], v[92:95], v[184:187], v[28:31]
    buffer_load_dwordx4 v[164:167], v232, s[40:43], s59 offen sc1
    v_mfma_f32_16x16x32_bf16 v[44:47], v[92:95], v[188:191], v[44:47]
    buffer_load_dwordx4 v[168:171], v233, s[40:43], s59 offen sc1
    v_mfma_f32_16x16x32_bf16 v[60:63], v[92:95], v[192:195], v[60:63]
    buffer_load_dwordx4 v[172:175], v234, s[40:43], s59 offen sc1
    v_mfma_f32_16x16x32_bf16 v[16:19], v[96:99], v[180:183], v[16:19]
    buffer_load_dwordx4 v[176:179], v235, s[40:43], s59 offen sc1
    v_mfma_f32_16x16x32_bf16 v[32:35], v[96:99], v[184:187], v[32:35]
    v_mfma_f32_16x16x32_bf16 v[48:51], v[96:99], v[188:191], v[48:51]
    v_mfma_f32_16x16x32_bf16 v[64:67], v[96:99], v[192:195], v[64:67]
    s_waitcnt lgkmcnt(0)
    s_waitcnt vmcnt(19)
    v_mfma_f32_16x16x32_bf16 v[4:7], v[68:71], v[100:103], v[4:7]
    ds_read_b64_tr_b16 v[84:85], v220 offset:32768
    s_waitcnt vmcnt(18)
    v_mfma_f32_16x16x32_bf16 v[20:23], v[68:71], v[104:107], v[20:23]
    ds_read_b64_tr_b16 v[86:87], v220 offset:34816
    s_waitcnt vmcnt(17)
    v_mfma_f32_16x16x32_bf16 v[36:39], v[68:71], v[108:111], v[36:39]
    ds_read_b64_tr_b16 v[88:89], v221 offset:32768
    s_waitcnt vmcnt(16)
    v_mfma_f32_16x16x32_bf16 v[52:55], v[68:71], v[112:115], v[52:55]
    ds_read_b64_tr_b16 v[90:91], v221 offset:34816
    v_mfma_f32_16x16x32_bf16 v[8:11], v[72:75], v[100:103], v[8:11]
    ds_read_b64_tr_b16 v[92:93], v222 offset:32768
    v_mfma_f32_16x16x32_bf16 v[24:27], v[72:75], v[104:107], v[24:27]
    ds_read_b64_tr_b16 v[94:95], v222 offset:34816
    v_mfma_f32_16x16x32_bf16 v[40:43], v[72:75], v[108:111], v[40:43]
    ds_read_b64_tr_b16 v[96:97], v223 offset:32768
    v_mfma_f32_16x16x32_bf16 v[56:59], v[72:75], v[112:115], v[56:59]
    ds_read_b64_tr_b16 v[98:99], v223 offset:34816
    v_mfma_f32_16x16x32_bf16 v[12:15], v[76:79], v[100:103], v[12:15]
    s_add_u32 s58, s58, 2048
    s_add_u32 s59, s57, s58
    v_mfma_f32_16x16x32_bf16 v[28:31], v[76:79], v[104:107], v[28:31]
    buffer_load_dwordx4 v[180:183], v232, s[40:43], s59 offen sc1
    v_mfma_f32_16x16x32_bf16 v[44:47], v[76:79], v[108:111], v[44:47]
    buffer_load_dwordx4 v[184:187], v233, s[40:43], s59 offen sc1
    v_mfma_f32_16x16x32_bf16 v[60:63], v[76:79], v[112:115], v[60:63]
    buffer_load_dwordx4 v[188:191], v234, s[40:43], s59 offen sc1
    v_mfma_f32_16x16x32_bf16 v[16:19], v[80:83], v[100:103], v[16:19]
    buffer_load_dwordx4 v[192:195], v235, s[40:43], s59 offen sc1
    v_mfma_f32_16x16x32_bf16 v[32:35], v[80:83], v[104:107], v[32:35]
    v_mfma_f32_16x16x32_bf16 v[48:51], v[80:83], v[108:111], v[48:51]
    v_mfma_f32_16x16x32_bf16 v[64:67], v[80:83], v[112:115], v[64:67]
    s_waitcnt lgkmcnt(0)
    s_waitcnt vmcnt(19)
    v_mfma_f32_16x16x32_bf16 v[4:7], v[84:87], v[116:119], v[4:7]
    ds_read_b64_tr_b16 v[68:69], v220 offset:40960
    s_waitcnt vmcnt(18)
    v_mfma_f32_16x16x32_bf16 v[20:23], v[84:87], v[120:123], v[20:23]
    ds_read_b64_tr_b16 v[70:71], v220 offset:43008
    s_waitcnt vmcnt(17)
    v_mfma_f32_16x16x32_bf16 v[36:39], v[84:87], v[124:127], v[36:39]
    ds_read_b64_tr_b16 v[72:73], v221 offset:40960
    s_waitcnt vmcnt(16)
    v_mfma_f32_16x16x32_bf16 v[52:55], v[84:87], v[128:131], v[52:55]
    ds_read_b64_tr_b16 v[74:75], v221 offset:43008
    v_mfma_f32_16x16x32_bf16 v[8:11], v[88:91], v[116:119], v[8:11]
    ds_read_b64_tr_b16 v[76:77], v222 offset:40960
    v_mfma_f32_16x16x32_bf16 v[24:27], v[88:91], v[120:123], v[24:27]
    ds_read_b64_tr_b16 v[78:79], v222 offset:43008
    v_mfma_f32_16x16x32_bf16 v[40:43], v[88:91], v[124:127], v[40:43]
    ds_read_b64_tr_b16 v[80:81], v223 offset:40960
    v_mfma_f32_16x16x32_bf16 v[56:59], v[88:91], v[128:131], v[56:59]
    ds_read_b64_tr_b16 v[82:83], v223 offset:43008
    v_mfma_f32_16x16x32_bf16 v[12:15], v[92:95], v[116:119], v[12:15]
    s_add_u32 s58, s58, 2048
    s_cmp_eq_u32 s58, 55296
    v_mfma_f32_16x16x32_bf16 v[28:31], v[92:95], v[120:123], v[28:31]
    s_cselect_b32 s58, 0, s58
    s_add_u32 s59, s57, s58
    v_mfma_f32_16x16x32_bf16 v[44:47], v[92:95], v[124:127], v[44:47]
    buffer_load_dwordx4 v[100:103], v232, s[40:43], s59 offen sc1
    v_mfma_f32_16x16x32_bf16 v[60:63], v[92:95], v[128:131], v[60:63]
    buffer_load_dwordx4 v[104:107], v233, s[40:43], s59 offen sc1
    v_mfma_f32_16x16x32_bf16 v[16:19], v[96:99], v[116:119], v[16:19]
    buffer_load_dwordx4 v[108:111], v234, s[40:43], s59 offen sc1
    v_mfma_f32_16x16x32_bf16 v[32:35], v[96:99], v[120:123], v[32:35]
    buffer_load_dwordx4 v[112:115], v235, s[40:43], s59 offen sc1
    v_mfma_f32_16x16x32_bf16 v[48:51], v[96:99], v[124:127], v[48:51]
    v_mfma_f32_16x16x32_bf16 v[64:67], v[96:99], v[128:131], v[64:67]
    s_waitcnt lgkmcnt(0)
    s_barrier
    s_waitcnt vmcnt(19)
    v_mfma_f32_16x16x32_bf16 v[4:7], v[68:71], v[132:135], v[4:7]
    ds_read_b64_tr_b16 v[84:85], v224 offset:0
    s_waitcnt vmcnt(18)
    v_mfma_f32_16x16x32_bf16 v[20:23], v[68:71], v[136:139], v[20:23]
    ds_read_b64_tr_b16 v[86:87], v224 offset:2048
    s_waitcnt vmcnt(17)
    v_mfma_f32_16x16x32_bf16 v[36:39], v[68:71], v[140:143], v[36:39]
    ds_read_b64_tr_b16 v[88:89], v225 offset:0
    s_waitcnt vmcnt(16)
    v_mfma_f32_16x16x32_bf16 v[52:55], v[68:71], v[144:147], v[52:55]
    ds_read_b64_tr_b16 v[90:91], v225 offset:2048
    v_mfma_f32_16x16x32_bf16 v[8:11], v[72:75], v[132:135], v[8:11]
    ds_read_b64_tr_b16 v[92:93], v226 offset:0
    v_mfma_f32_16x16x32_bf16 v[24:27], v[72:75], v[136:139], v[24:27]
    ds_read_b64_tr_b16 v[94:95], v226 offset:2048
    v_mfma_f32_16x16x32_bf16 v[40:43], v[72:75], v[140:143], v[40:43]
    ds_read_b64_tr_b16 v[96:97], v227 offset:0
    v_mfma_f32_16x16x32_bf16 v[56:59], v[72:75], v[144:147], v[56:59]
    ds_read_b64_tr_b16 v[98:99], v227 offset:2048
    v_mfma_f32_16x16x32_bf16 v[12:15], v[76:79], v[132:135], v[12:15]
    s_add_u32 s58, s58, 2048
    s_add_u32 s59, s57, s58
    v_mfma_f32_16x16x32_bf16 v[28:31], v[76:79], v[136:139], v[28:31]
    buffer_load_dwordx4 v[116:119], v232, s[40:43], s59 offen sc1
    v_mfma_f32_16x16x32_bf16 v[44:47], v[76:79], v[140:143], v[44:47]
    buffer_load_dwordx4 v[120:123], v233, s[40:43], s59 offen sc1
    v_mfma_f32_16x16x32_bf16 v[60:63], v[76:79], v[144:147], v[60:63]
    buffer_load_dwordx4 v[124:127], v234, s[40:43], s59 offen sc1
    v_mfma_f32_16x16x32_bf16 v[16:19], v[80:83], v[132:135], v[16:19]
    buffer_load_dwordx4 v[128:131], v235, s[40:43], s59 offen sc1
    v_mfma_f32_16x16x32_bf16 v[32:35], v[80:83], v[136:139], v[32:35]
    v_mfma_f32_16x16x32_bf16 v[48:51], v[80:83], v[140:143], v[48:51]
    v_mfma_f32_16x16x32_bf16 v[64:67], v[80:83], v[144:147], v[64:67]
    s_waitcnt lgkmcnt(0)
    s_waitcnt vmcnt(19)
    v_mfma_f32_16x16x32_bf16 v[4:7], v[84:87], v[148:151], v[4:7]
    ds_read_b64_tr_b16 v[68:69], v224 offset:8192
    s_waitcnt vmcnt(18)
    v_mfma_f32_16x16x32_bf16 v[20:23], v[84:87], v[152:155], v[20:23]
    ds_read_b64_tr_b16 v[70:71], v224 offset:10240
    s_waitcnt vmcnt(17)
    v_mfma_f32_16x16x32_bf16 v[36:39], v[84:87], v[156:159], v[36:39]
    ds_read_b64_tr_b16 v[72:73], v225 offset:8192
    s_waitcnt vmcnt(16)
    v_mfma_f32_16x16x32_bf16 v[52:55], v[84:87], v[160:163], v[52:55]
    ds_read_b64_tr_b16 v[74:75], v225 offset:10240
    v_mfma_f32_16x16x32_bf16 v[8:11], v[88:91], v[148:151], v[8:11]
    ds_read_b64_tr_b16 v[76:77], v226 offset:8192
    v_mfma_f32_16x16x32_bf16 v[24:27], v[88:91], v[152:155], v[24:27]
    ds_read_b64_tr_b16 v[78:79], v226 offset:10240
    v_mfma_f32_16x16x32_bf16 v[40:43], v[88:91], v[156:159], v[40:43]
    ds_read_b64_tr_b16 v[80:81], v227 offset:8192
    v_mfma_f32_16x16x32_bf16 v[56:59], v[88:91], v[160:163], v[56:59]
    ds_read_b64_tr_b16 v[82:83], v227 offset:10240
    v_mfma_f32_16x16x32_bf16 v[12:15], v[92:95], v[148:151], v[12:15]
    s_add_u32 s58, s58, 2048
    s_add_u32 s59, s57, s58
    v_mfma_f32_16x16x32_bf16 v[28:31], v[92:95], v[152:155], v[28:31]
    buffer_load_dwordx4 v[132:135], v232, s[40:43], s59 offen sc1
    v_mfma_f32_16x16x32_bf16 v[44:47], v[92:95], v[156:159], v[44:47]
    buffer_load_dwordx4 v[136:139], v233, s[40:43], s59 offen sc1
    v_mfma_f32_16x16x32_bf16 v[60:63], v[92:95], v[160:163], v[60:63]
    buffer_load_dwordx4 v[140:143], v234, s[40:43], s59 offen sc1
    v_mfma_f32_16x16x32_bf16 v[16:19], v[96:99], v[148:151], v[16:19]
    buffer_load_dwordx4 v[144:147], v235, s[40:43], s59 offen sc1
    v_mfma_f32_16x16x32_bf16 v[32:35], v[96:99], v[152:155], v[32:35]
    v_mfma_f32_16x16x32_bf16 v[48:51], v[96:99], v[156:159], v[48:51]
    v_mfma_f32_16x16x32_bf16 v[64:67], v[96:99], v[160:163], v[64:67]
    s_waitcnt lgkmcnt(0)
    s_waitcnt vmcnt(19)
    v_mfma_f32_16x16x32_bf16 v[4:7], v[68:71], v[164:167], v[4:7]
    ds_read_b64_tr_b16 v[84:85], v224 offset:16384
    s_waitcnt vmcnt(18)
    v_mfma_f32_16x16x32_bf16 v[20:23], v[68:71], v[168:171], v[20:23]
    ds_read_b64_tr_b16 v[86:87], v224 offset:18432
    s_waitcnt vmcnt(17)
    v_mfma_f32_16x16x32_bf16 v[36:39], v[68:71], v[172:175], v[36:39]
    ds_read_b64_tr_b16 v[88:89], v225 offset:16384
    s_waitcnt vmcnt(16)
    v_mfma_f32_16x16x32_bf16 v[52:55], v[68:71], v[176:179], v[52:55]
    ds_read_b64_tr_b16 v[90:91], v225 offset:18432
    v_mfma_f32_16x16x32_bf16 v[8:11], v[72:75], v[164:167], v[8:11]
    ds_read_b64_tr_b16 v[92:93], v226 offset:16384
    v_mfma_f32_16x16x32_bf16 v[24:27], v[72:75], v[168:171], v[24:27]
    ds_read_b64_tr_b16 v[94:95], v226 offset:18432
    v_mfma_f32_16x16x32_bf16 v[40:43], v[72:75], v[172:175], v[40:43]
    ds_read_b64_tr_b16 v[96:97], v227 offset:16384
    v_mfma_f32_16x16x32_bf16 v[56:59], v[72:75], v[176:179], v[56:59]
    ds_read_b64_tr_b16 v[98:99], v227 offset:18432
    v_mfma_f32_16x16x32_bf16 v[12:15], v[76:79], v[164:167], v[12:15]
    s_add_u32 s58, s58, 2048
    s_cmp_eq_u32 s58, 55296
    v_mfma_f32_16x16x32_bf16 v[28:31], v[76:79], v[168:171], v[28:31]
    s_cselect_b32 s58, 0, s58
    s_add_u32 s59, s57, s58
    v_mfma_f32_16x16x32_bf16 v[44:47], v[76:79], v[172:175], v[44:47]
    buffer_load_dwordx4 v[148:151], v232, s[40:43], s59 offen sc1
    v_mfma_f32_16x16x32_bf16 v[60:63], v[76:79], v[176:179], v[60:63]
    buffer_load_dwordx4 v[152:155], v233, s[40:43], s59 offen sc1
    v_mfma_f32_16x16x32_bf16 v[16:19], v[80:83], v[164:167], v[16:19]
    buffer_load_dwordx4 v[156:159], v234, s[40:43], s59 offen sc1
    v_mfma_f32_16x16x32_bf16 v[32:35], v[80:83], v[168:171], v[32:35]
    buffer_load_dwordx4 v[160:163], v235, s[40:43], s59 offen sc1
    v_mfma_f32_16x16x32_bf16 v[48:51], v[80:83], v[172:175], v[48:51]
    v_mfma_f32_16x16x32_bf16 v[64:67], v[80:83], v[176:179], v[64:67]
    s_waitcnt lgkmcnt(0)
    s_barrier
    s_waitcnt vmcnt(19)
    v_mfma_f32_16x16x32_bf16 v[4:7], v[84:87], v[180:183], v[4:7]
    ds_read_b64_tr_b16 v[68:69], v224 offset:24576
    s_waitcnt vmcnt(18)
    v_mfma_f32_16x16x32_bf16 v[20:23], v[84:87], v[184:187], v[20:23]
    ds_read_b64_tr_b16 v[70:71], v224 offset:26624
    s_waitcnt vmcnt(17)
    v_mfma_f32_16x16x32_bf16 v[36:39], v[84:87], v[188:191], v[36:39]
    ds_read_b64_tr_b16 v[72:73], v225 offset:24576
    s_waitcnt vmcnt(16)
    v_mfma_f32_16x16x32_bf16 v[52:55], v[84:87], v[192:195], v[52:55]
    ds_read_b64_tr_b16 v[74:75], v225 offset:26624
    v_mfma_f32_16x16x32_bf16 v[8:11], v[88:91], v[180:183], v[8:11]
    ds_read_b64_tr_b16 v[76:77], v226 offset:24576
    v_mfma_f32_16x16x32_bf16 v[24:27], v[88:91], v[184:187], v[24:27]
    ds_read_b64_tr_b16 v[78:79], v226 offset:26624
    v_mfma_f32_16x16x32_bf16 v[40:43], v[88:91], v[188:191], v[40:43]
    ds_read_b64_tr_b16 v[80:81], v227 offset:24576
    v_mfma_f32_16x16x32_bf16 v[56:59], v[88:91], v[192:195], v[56:59]
    ds_read_b64_tr_b16 v[82:83], v227 offset:26624
    v_mfma_f32_16x16x32_bf16 v[12:15], v[92:95], v[180:183], v[12:15]
    s_add_u32 s58, s58, 2048
    s_add_u32 s59, s57, s58
    v_mfma_f32_16x16x32_bf16 v[28:31], v[92:95], v[184:187], v[28:31]
    buffer_load_dwordx4 v[164:167], v232, s[40:43], s59 offen sc1
    v_mfma_f32_16x16x32_bf16 v[44:47], v[92:95], v[188:191], v[44:47]
    buffer_load_dwordx4 v[168:171], v233, s[40:43], s59 offen sc1
    v_mfma_f32_16x16x32_bf16 v[60:63], v[92:95], v[192:195], v[60:63]
    buffer_load_dwordx4 v[172:175], v234, s[40:43], s59 offen sc1
    v_mfma_f32_16x16x32_bf16 v[16:19], v[96:99], v[180:183], v[16:19]
    buffer_load_dwordx4 v[176:179], v235, s[40:43], s59 offen sc1
    v_mfma_f32_16x16x32_bf16 v[32:35], v[96:99], v[184:187], v[32:35]
    v_mfma_f32_16x16x32_bf16 v[48:51], v[96:99], v[188:191], v[48:51]
    v_mfma_f32_16x16x32_bf16 v[64:67], v[96:99], v[192:195], v[64:67]
    s_waitcnt lgkmcnt(0)
    s_waitcnt vmcnt(19)
    v_mfma_f32_16x16x32_bf16 v[4:7], v[68:71], v[100:103], v[4:7]
    ds_read_b64_tr_b16 v[84:85], v224 offset:32768
    s_waitcnt vmcnt(18)
    v_mfma_f32_16x16x32_bf16 v[20:23], v[68:71], v[104:107], v[20:23]
    ds_read_b64_tr_b16 v[86:87], v224 offset:34816
    s_waitcnt vmcnt(17)
    v_mfma_f32_16x16x32_bf16 v[36:39], v[68:71], v[108:111], v[36:39]
    ds_read_b64_tr_b16 v[88:89], v225 offset:32768
    s_waitcnt vmcnt(16)
    v_mfma_f32_16x16x32_bf16 v[52:55], v[68:71], v[112:115], v[52:55]
    ds_read_b64_tr_b16 v[90:91], v225 offset:34816
    v_mfma_f32_16x16x32_bf16 v[8:11], v[72:75], v[100:103], v[8:11]
    ds_read_b64_tr_b16 v[92:93], v226 offset:32768
    v_mfma_f32_16x16x32_bf16 v[24:27], v[72:75], v[104:107], v[24:27]
    ds_read_b64_tr_b16 v[94:95], v226 offset:34816
    v_mfma_f32_16x16x32_bf16 v[40:43], v[72:75], v[108:111], v[40:43]
    ds_read_b64_tr_b16 v[96:97], v227 offset:32768
    v_mfma_f32_16x16x32_bf16 v[56:59], v[72:75], v[112:115], v[56:59]
    ds_read_b64_tr_b16 v[98:99], v227 offset:34816
    v_mfma_f32_16x16x32_bf16 v[12:15], v[76:79], v[100:103], v[12:15]
    s_add_u32 s58, s58, 2048
    s_add_u32 s59, s57, s58
    v_mfma_f32_16x16x32_bf16 v[28:31], v[76:79], v[104:107], v[28:31]
    buffer_load_dwordx4 v[180:183], v232, s[40:43], s59 offen sc1
    v_mfma_f32_16x16x32_bf16 v[44:47], v[76:79], v[108:111], v[44:47]
    buffer_load_dwordx4 v[184:187], v233, s[40:43], s59 offen sc1
    v_mfma_f32_16x16x32_bf16 v[60:63], v[76:79], v[112:115], v[60:63]
    buffer_load_dwordx4 v[188:191], v234, s[40:43], s59 offen sc1
    v_mfma_f32_16x16x32_bf16 v[16:19], v[80:83], v[100:103], v[16:19]
    buffer_load_dwordx4 v[192:195], v235, s[40:43], s59 offen sc1
    v_mfma_f32_16x16x32_bf16 v[32:35], v[80:83], v[104:107], v[32:35]
    v_mfma_f32_16x16x32_bf16 v[48:51], v[80:83], v[108:111], v[48:51]
    v_mfma_f32_16x16x32_bf16 v[64:67], v[80:83], v[112:115], v[64:67]
    s_waitcnt lgkmcnt(0)
    s_waitcnt vmcnt(19)
    v_mfma_f32_16x16x32_bf16 v[4:7], v[84:87], v[116:119], v[4:7]
    ds_read_b64_tr_b16 v[68:69], v224 offset:40960
    s_waitcnt vmcnt(18)
    v_mfma_f32_16x16x32_bf16 v[20:23], v[84:87], v[120:123], v[20:23]
    ds_read_b64_tr_b16 v[70:71], v224 offset:43008
    s_waitcnt vmcnt(17)
    v_mfma_f32_16x16x32_bf16 v[36:39], v[84:87], v[124:127], v[36:39]
    ds_read_b64_tr_b16 v[72:73], v225 offset:40960
    s_waitcnt vmcnt(16)
    v_mfma_f32_16x16x32_bf16 v[52:55], v[84:87], v[128:131], v[52:55]
    ds_read_b64_tr_b16 v[74:75], v225 offset:43008
    v_mfma_f32_16x16x32_bf16 v[8:11], v[88:91], v[116:119], v[8:11]
    ds_read_b64_tr_b16 v[76:77], v226 offset:40960
    v_mfma_f32_16x16x32_bf16 v[24:27], v[88:91], v[120:123], v[24:27]
    ds_read_b64_tr_b16 v[78:79], v226 offset:43008
    v_mfma_f32_16x16x32_bf16 v[40:43], v[88:91], v[124:127], v[40:43]
    ds_read_b64_tr_b16 v[80:81], v227 offset:40960
    v_mfma_f32_16x16x32_bf16 v[56:59], v[88:91], v[128:131], v[56:59]
    ds_read_b64_tr_b16 v[82:83], v227 offset:43008
    v_mfma_f32_16x16x32_bf16 v[12:15], v[92:95], v[116:119], v[12:15]
    s_add_u32 s58, s58, 2048
    s_cmp_eq_u32 s58, 55296
    v_mfma_f32_16x16x32_bf16 v[28:31], v[92:95], v[120:123], v[28:31]
    s_cselect_b32 s58, 0, s58
    s_add_u32 s59, s57, s58
    v_mfma_f32_16x16x32_bf16 v[44:47], v[92:95], v[124:127], v[44:47]
    buffer_load_dwordx4 v[100:103], v232, s[40:43], s59 offen sc1
    v_mfma_f32_16x16x32_bf16 v[60:63], v[92:95], v[128:131], v[60:63]
    buffer_load_dwordx4 v[104:107], v233, s[40:43], s59 offen sc1
    v_mfma_f32_16x16x32_bf16 v[16:19], v[96:99], v[116:119], v[16:19]
    buffer_load_dwordx4 v[108:111], v234, s[40:43], s59 offen sc1
    v_mfma_f32_16x16x32_bf16 v[32:35], v[96:99], v[120:123], v[32:35]
    buffer_load_dwordx4 v[112:115], v235, s[40:43], s59 offen sc1
    v_mfma_f32_16x16x32_bf16 v[48:51], v[96:99], v[124:127], v[48:51]
    v_mfma_f32_16x16x32_bf16 v[64:67], v[96:99], v[128:131], v[64:67]
    s_waitcnt lgkmcnt(0)
    s_barrier
    s_waitcnt vmcnt(19)
    v_mfma_f32_16x16x32_bf16 v[4:7], v[68:71], v[132:135], v[4:7]
    ds_read_b64_tr_b16 v[84:85], v228 offset:0
    s_waitcnt vmcnt(18)
    v_mfma_f32_16x16x32_bf16 v[20:23], v[68:71], v[136:139], v[20:23]
    ds_read_b64_tr_b16 v[86:87], v228 offset:2048
    s_waitcnt vmcnt(17)
    v_mfma_f32_16x16x32_bf16 v[36:39], v[68:71], v[140:143], v[36:39]
    ds_read_b64_tr_b16 v[88:89], v229 offset:0
    s_waitcnt vmcnt(16)
    v_mfma_f32_16x16x32_bf16 v[52:55], v[68:71], v[144:147], v[52:55]
    ds_read_b64_tr_b16 v[90:91], v229 offset:2048
    v_mfma_f32_16x16x32_bf16 v[8:11], v[72:75], v[132:135], v[8:11]
    ds_read_b64_tr_b16 v[92:93], v230 offset:0
    v_mfma_f32_16x16x32_bf16 v[24:27], v[72:75], v[136:139], v[24:27]
    ds_read_b64_tr_b16 v[94:95], v230 offset:2048
    v_mfma_f32_16x16x32_bf16 v[40:43], v[72:75], v[140:143], v[40:43]
    ds_read_b64_tr_b16 v[96:97], v231 offset:0
    v_mfma_f32_16x16x32_bf16 v[56:59], v[72:75], v[144:147], v[56:59]
    ds_read_b64_tr_b16 v[98:99], v231 offset:2048
    v_mfma_f32_16x16x32_bf16 v[12:15], v[76:79], v[132:135], v[12:15]
    s_add_u32 s58, s58, 2048
    s_add_u32 s59, s57, s58
    v_mfma_f32_16x16x32_bf16 v[28:31], v[76:79], v[136:139], v[28:31]
    buffer_load_dwordx4 v[116:119], v232, s[40:43], s59 offen sc1
    v_mfma_f32_16x16x32_bf16 v[44:47], v[76:79], v[140:143], v[44:47]
    buffer_load_dwordx4 v[120:123], v233, s[40:43], s59 offen sc1
    v_mfma_f32_16x16x32_bf16 v[60:63], v[76:79], v[144:147], v[60:63]
    buffer_load_dwordx4 v[124:127], v234, s[40:43], s59 offen sc1
    v_mfma_f32_16x16x32_bf16 v[16:19], v[80:83], v[132:135], v[16:19]
    buffer_load_dwordx4 v[128:131], v235, s[40:43], s59 offen sc1
    v_mfma_f32_16x16x32_bf16 v[32:35], v[80:83], v[136:139], v[32:35]
    v_mfma_f32_16x16x32_bf16 v[48:51], v[80:83], v[140:143], v[48:51]
    v_mfma_f32_16x16x32_bf16 v[64:67], v[80:83], v[144:147], v[64:67]
    s_waitcnt lgkmcnt(0)
    s_waitcnt vmcnt(19)
    v_mfma_f32_16x16x32_bf16 v[4:7], v[84:87], v[148:151], v[4:7]
    ds_read_b64_tr_b16 v[68:69], v228 offset:8192
    s_waitcnt vmcnt(18)
    v_mfma_f32_16x16x32_bf16 v[20:23], v[84:87], v[152:155], v[20:23]
    ds_read_b64_tr_b16 v[70:71], v228 offset:10240
    s_waitcnt vmcnt(17)
    v_mfma_f32_16x16x32_bf16 v[36:39], v[84:87], v[156:159], v[36:39]
    ds_read_b64_tr_b16 v[72:73], v229 offset:8192
    s_waitcnt vmcnt(16)
    v_mfma_f32_16x16x32_bf16 v[52:55], v[84:87], v[160:163], v[52:55]
    ds_read_b64_tr_b16 v[74:75], v229 offset:10240
    v_mfma_f32_16x16x32_bf16 v[8:11], v[88:91], v[148:151], v[8:11]
    ds_read_b64_tr_b16 v[76:77], v230 offset:8192
    v_mfma_f32_16x16x32_bf16 v[24:27], v[88:91], v[152:155], v[24:27]
    ds_read_b64_tr_b16 v[78:79], v230 offset:10240
    v_mfma_f32_16x16x32_bf16 v[40:43], v[88:91], v[156:159], v[40:43]
    ds_read_b64_tr_b16 v[80:81], v231 offset:8192
    v_mfma_f32_16x16x32_bf16 v[56:59], v[88:91], v[160:163], v[56:59]
    ds_read_b64_tr_b16 v[82:83], v231 offset:10240
    v_mfma_f32_16x16x32_bf16 v[12:15], v[92:95], v[148:151], v[12:15]
    s_add_u32 s58, s58, 2048
    s_add_u32 s59, s57, s58
    v_mfma_f32_16x16x32_bf16 v[28:31], v[92:95], v[152:155], v[28:31]
    buffer_load_dwordx4 v[132:135], v232, s[40:43], s59 offen sc1
    v_mfma_f32_16x16x32_bf16 v[44:47], v[92:95], v[156:159], v[44:47]
    buffer_load_dwordx4 v[136:139], v233, s[40:43], s59 offen sc1
    v_mfma_f32_16x16x32_bf16 v[60:63], v[92:95], v[160:163], v[60:63]
    buffer_load_dwordx4 v[140:143], v234, s[40:43], s59 offen sc1
    v_mfma_f32_16x16x32_bf16 v[16:19], v[96:99], v[148:151], v[16:19]
    buffer_load_dwordx4 v[144:147], v235, s[40:43], s59 offen sc1
    v_mfma_f32_16x16x32_bf16 v[32:35], v[96:99], v[152:155], v[32:35]
    v_lshrrev_b32 v242, 3, v0
    v_and_b32 v241, 7, v0
    v_mfma_f32_16x16x32_bf16 v[48:51], v[96:99], v[156:159], v[48:51]
    v_lshlrev_b32 v241, 2, v241
    v_lshl_add_u32 v241, v242, 7, v241
    v_mfma_f32_16x16x32_bf16 v[64:67], v[96:99], v[160:163], v[64:67]
    s_lshl_b32 s56, s63, 10
    s_add_u32 s56, s56, 0xe10000
    buffer_load_dword v242, v241, s[40:43], s56 offen sc1
    s_waitcnt lgkmcnt(0)
    s_waitcnt vmcnt(20)
    v_mfma_f32_16x16x32_bf16 v[4:7], v[68:71], v[164:167], v[4:7]
    ds_read_b64_tr_b16 v[84:85], v228 offset:16384
    s_waitcnt vmcnt(19)
    v_mfma_f32_16x16x32_bf16 v[20:23], v[68:71], v[168:171], v[20:23]
    ds_read_b64_tr_b16 v[86:87], v228 offset:18432
    s_waitcnt vmcnt(18)
    v_mfma_f32_16x16x32_bf16 v[36:39], v[68:71], v[172:175], v[36:39]
    ds_read_b64_tr_b16 v[88:89], v229 offset:16384
    s_waitcnt vmcnt(17)
    v_mfma_f32_16x16x32_bf16 v[52:55], v[68:71], v[176:179], v[52:55]
    ds_read_b64_tr_b16 v[90:91], v229 offset:18432
    v_mfma_f32_16x16x32_bf16 v[8:11], v[72:75], v[164:167], v[8:11]
    ds_read_b64_tr_b16 v[92:93], v230 offset:16384
    v_mfma_f32_16x16x32_bf16 v[24:27], v[72:75], v[168:171], v[24:27]
    ds_read_b64_tr_b16 v[94:95], v230 offset:18432
    v_mfma_f32_16x16x32_bf16 v[40:43], v[72:75], v[172:175], v[40:43]
    ds_read_b64_tr_b16 v[96:97], v231 offset:16384
    v_mfma_f32_16x16x32_bf16 v[56:59], v[72:75], v[176:179], v[56:59]
    ds_read_b64_tr_b16 v[98:99], v231 offset:18432
    v_mfma_f32_16x16x32_bf16 v[12:15], v[76:79], v[164:167], v[12:15]
    v_mfma_f32_16x16x32_bf16 v[28:31], v[76:79], v[168:171], v[28:31]
    v_mfma_f32_16x16x32_bf16 v[44:47], v[76:79], v[172:175], v[44:47]
    v_mfma_f32_16x16x32_bf16 v[60:63], v[76:79], v[176:179], v[60:63]
    v_mfma_f32_16x16x32_bf16 v[16:19], v[80:83], v[164:167], v[16:19]
    v_mfma_f32_16x16x32_bf16 v[32:35], v[80:83], v[168:171], v[32:35]
    v_mfma_f32_16x16x32_bf16 v[48:51], v[80:83], v[172:175], v[48:51]
    v_mfma_f32_16x16x32_bf16 v[64:67], v[80:83], v[176:179], v[64:67]
    s_waitcnt lgkmcnt(0)
    s_barrier
    s_waitcnt vmcnt(16)
    v_mfma_f32_16x16x32_bf16 v[4:7], v[84:87], v[180:183], v[4:7]
    ds_read_b64_tr_b16 v[68:69], v228 offset:24576
    s_waitcnt vmcnt(15)
    v_mfma_f32_16x16x32_bf16 v[20:23], v[84:87], v[184:187], v[20:23]
    ds_read_b64_tr_b16 v[70:71], v228 offset:26624
    s_waitcnt vmcnt(14)
    v_mfma_f32_16x16x32_bf16 v[36:39], v[84:87], v[188:191], v[36:39]
    ds_read_b64_tr_b16 v[72:73], v229 offset:24576
    s_waitcnt vmcnt(13)
    v_mfma_f32_16x16x32_bf16 v[52:55], v[84:87], v[192:195], v[52:55]
    ds_read_b64_tr_b16 v[74:75], v229 offset:26624
    v_mfma_f32_16x16x32_bf16 v[8:11], v[88:91], v[180:183], v[8:11]
    ds_read_b64_tr_b16 v[76:77], v230 offset:24576
    v_mfma_f32_16x16x32_bf16 v[24:27], v[88:91], v[184:187], v[24:27]
    ds_read_b64_tr_b16 v[78:79], v230 offset:26624
    v_mfma_f32_16x16x32_bf16 v[40:43], v[88:91], v[188:191], v[40:43]
    ds_read_b64_tr_b16 v[80:81], v231 offset:24576
    v_mfma_f32_16x16x32_bf16 v[56:59], v[88:91], v[192:195], v[56:59]
    ds_read_b64_tr_b16 v[82:83], v231 offset:26624
    v_mfma_f32_16x16x32_bf16 v[12:15], v[92:95], v[180:183], v[12:15]
    v_mfma_f32_16x16x32_bf16 v[28:31], v[92:95], v[184:187], v[28:31]
    v_mfma_f32_16x16x32_bf16 v[44:47], v[92:95], v[188:191], v[44:47]
    v_mfma_f32_16x16x32_bf16 v[60:63], v[92:95], v[192:195], v[60:63]
    v_mfma_f32_16x16x32_bf16 v[16:19], v[96:99], v[180:183], v[16:19]
    v_mfma_f32_16x16x32_bf16 v[32:35], v[96:99], v[184:187], v[32:35]
    v_mfma_f32_16x16x32_bf16 v[48:51], v[96:99], v[188:191], v[48:51]
    v_mfma_f32_16x16x32_bf16 v[64:67], v[96:99], v[192:195], v[64:67]
    s_waitcnt lgkmcnt(0)
    s_waitcnt vmcnt(0)
    s_waitcnt vmcnt(12)
    v_mfma_f32_16x16x32_bf16 v[4:7], v[68:71], v[100:103], v[4:7]
    ds_read_b64_tr_b16 v[84:85], v228 offset:32768
    s_waitcnt vmcnt(11)
    v_mfma_f32_16x16x32_bf16 v[20:23], v[68:71], v[104:107], v[20:23]
    ds_read_b64_tr_b16 v[86:87], v228 offset:34816
    s_waitcnt vmcnt(10)
    v_mfma_f32_16x16x32_bf16 v[36:39], v[68:71], v[108:111], v[36:39]
    ds_read_b64_tr_b16 v[88:89], v229 offset:32768
    s_waitcnt vmcnt(9)
    v_mfma_f32_16x16x32_bf16 v[52:55], v[68:71], v[112:115], v[52:55]
    ds_read_b64_tr_b16 v[90:91], v229 offset:34816
    v_mfma_f32_16x16x32_bf16 v[8:11], v[72:75], v[100:103], v[8:11]
    ds_read_b64_tr_b16 v[92:93], v230 offset:32768
    v_mfma_f32_16x16x32_bf16 v[24:27], v[72:75], v[104:107], v[24:27]
    ds_read_b64_tr_b16 v[94:95], v230 offset:34816
    v_mfma_f32_16x16x32_bf16 v[40:43], v[72:75], v[108:111], v[40:43]
    ds_read_b64_tr_b16 v[96:97], v231 offset:32768
    v_mfma_f32_16x16x32_bf16 v[56:59], v[72:75], v[112:115], v[56:59]
    ds_read_b64_tr_b16 v[98:99], v231 offset:34816
    v_mfma_f32_16x16x32_bf16 v[12:15], v[76:79], v[100:103], v[12:15]
    buffer_load_dwordx4 v[196:199], v237, s[40:43], s55 offen sc1
    v_mfma_f32_16x16x32_bf16 v[28:31], v[76:79], v[104:107], v[28:31]
    s_add_u32 s55, s55, 0x10000
    buffer_load_dwordx4 v[200:203], v237, s[40:43], s55 offen sc1
    v_mfma_f32_16x16x32_bf16 v[44:47], v[76:79], v[108:111], v[44:47]
    s_add_u32 s55, s55, 0x10000
    buffer_load_dwordx4 v[204:207], v237, s[40:43], s55 offen sc1
    v_mfma_f32_16x16x32_bf16 v[60:63], v[76:79], v[112:115], v[60:63]
    s_add_u32 s55, s55, 0x10000
    buffer_load_dwordx4 v[208:211], v237, s[40:43], s55 offen sc1
    v_mfma_f32_16x16x32_bf16 v[16:19], v[80:83], v[100:103], v[16:19]
    s_sub_u32 s55, s55, 0x30000
    v_mfma_f32_16x16x32_bf16 v[32:35], v[80:83], v[104:107], v[32:35]
    v_mfma_f32_16x16x32_bf16 v[48:51], v[80:83], v[108:111], v[48:51]
    v_mfma_f32_16x16x32_bf16 v[64:67], v[80:83], v[112:115], v[64:67]
    s_waitcnt lgkmcnt(0)
    s_waitcnt vmcnt(12)
    v_mfma_f32_16x16x32_bf16 v[4:7], v[84:87], v[116:119], v[4:7]
    ds_read_b64_tr_b16 v[68:69], v228 offset:40960
    s_waitcnt vmcnt(11)
    v_mfma_f32_16x16x32_bf16 v[20:23], v[84:87], v[120:123], v[20:23]
    ds_read_b64_tr_b16 v[70:71], v228 offset:43008
    s_waitcnt vmcnt(10)
    v_mfma_f32_16x16x32_bf16 v[36:39], v[84:87], v[124:127], v[36:39]
    ds_read_b64_tr_b16 v[72:73], v229 offset:40960
    s_waitcnt vmcnt(9)
    v_mfma_f32_16x16x32_bf16 v[52:55], v[84:87], v[128:131], v[52:55]
    ds_read_b64_tr_b16 v[74:75], v229 offset:43008
    v_mfma_f32_16x16x32_bf16 v[8:11], v[88:91], v[116:119], v[8:11]
    ds_read_b64_tr_b16 v[76:77], v230 offset:40960
    v_mfma_f32_16x16x32_bf16 v[24:27], v[88:91], v[120:123], v[24:27]
    ds_read_b64_tr_b16 v[78:79], v230 offset:43008
    v_mfma_f32_16x16x32_bf16 v[40:43], v[88:91], v[124:127], v[40:43]
    ds_read_b64_tr_b16 v[80:81], v231 offset:40960
    v_mfma_f32_16x16x32_bf16 v[56:59], v[88:91], v[128:131], v[56:59]
    ds_read_b64_tr_b16 v[82:83], v231 offset:43008
    v_mfma_f32_16x16x32_bf16 v[12:15], v[92:95], v[116:119], v[12:15]
    v_mfma_f32_16x16x32_bf16 v[28:31], v[92:95], v[120:123], v[28:31]
    v_mfma_f32_16x16x32_bf16 v[44:47], v[92:95], v[124:127], v[44:47]
    v_mfma_f32_16x16x32_bf16 v[60:63], v[92:95], v[128:131], v[60:63]
    v_mfma_f32_16x16x32_bf16 v[16:19], v[96:99], v[116:119], v[16:19]
    v_mfma_f32_16x16x32_bf16 v[32:35], v[96:99], v[120:123], v[32:35]
    v_mfma_f32_16x16x32_bf16 v[48:51], v[96:99], v[124:127], v[48:51]
    v_mfma_f32_16x16x32_bf16 v[64:67], v[96:99], v[128:131], v[64:67]
    s_waitcnt lgkmcnt(0)
    s_waitcnt vmcnt(8)
    v_mfma_f32_16x16x32_bf16 v[4:7], v[68:71], v[132:135], v[4:7]
    s_waitcnt vmcnt(7)
    v_mfma_f32_16x16x32_bf16 v[20:23], v[68:71], v[136:139], v[20:23]
    s_waitcnt vmcnt(6)
    v_mfma_f32_16x16x32_bf16 v[36:39], v[68:71], v[140:143], v[36:39]
    s_waitcnt vmcnt(5)
    v_mfma_f32_16x16x32_bf16 v[52:55], v[68:71], v[144:147], v[52:55]
    v_mfma_f32_16x16x32_bf16 v[8:11], v[72:75], v[132:135], v[8:11]
    v_mfma_f32_16x16x32_bf16 v[24:27], v[72:75], v[136:139], v[24:27]
    v_mfma_f32_16x16x32_bf16 v[40:43], v[72:75], v[140:143], v[40:43]
    v_mfma_f32_16x16x32_bf16 v[56:59], v[72:75], v[144:147], v[56:59]
    v_mfma_f32_16x16x32_bf16 v[12:15], v[76:79], v[132:135], v[12:15]
    v_mfma_f32_16x16x32_bf16 v[28:31], v[76:79], v[136:139], v[28:31]
    v_mfma_f32_16x16x32_bf16 v[44:47], v[76:79], v[140:143], v[44:47]
    v_mfma_f32_16x16x32_bf16 v[60:63], v[76:79], v[144:147], v[60:63]
    v_mfma_f32_16x16x32_bf16 v[16:19], v[80:83], v[132:135], v[16:19]
    v_mfma_f32_16x16x32_bf16 v[32:35], v[80:83], v[136:139], v[32:35]
    v_mfma_f32_16x16x32_bf16 v[48:51], v[80:83], v[140:143], v[48:51]
    v_mfma_f32_16x16x32_bf16 v[64:67], v[80:83], v[144:147], v[64:67]
    s_lshl_b32 s54, s30, 13
    s_add_u32 s54, s54, 73728
    v_add_u32 v240, s54, v236
    v_xor_b32 v232, 16384, v236
    s_lshl_b32 s54, s30, 13
    v_xor_b32 v232, s54, v232
    v_add_u32 v232, 73728, v232
    s_cmp_lg_u32 s53, 0
    s_cbranch_scc1 g2_k1_15
    ds_write_b128 v240, v[36:39] offset:0
    ds_write_b128 v240, v[40:43] offset:1024
    ds_write_b128 v240, v[44:47] offset:2048
    ds_write_b128 v240, v[48:51] offset:3072
    ds_write_b128 v240, v[52:55] offset:4096
    ds_write_b128 v240, v[56:59] offset:5120
    ds_write_b128 v240, v[60:63] offset:6144
    ds_write_b128 v240, v[64:67] offset:7168
    s_waitcnt lgkmcnt(0)
    s_barrier
    ds_read_b128 v[100:103], v232 offset:0
    ds_read_b128 v[104:107], v232 offset:1024
    ds_read_b128 v[108:111], v232 offset:2048
    ds_read_b128 v[112:115], v232 offset:3072
    ds_read_b128 v[116:119], v232 offset:4096
    ds_read_b128 v[120:123], v232 offset:5120
    ds_read_b128 v[124:127], v232 offset:6144
    ds_read_b128 v[128:131], v232 offset:7168
    s_waitcnt vmcnt(0)
    v_cmp_ne_u32 vcc, s67, v242
    s_cbranch_vccz xa_ok_17
xa_poll_18:
    buffer_load_dword v242, v241, s[40:43], s56 offen sc1
    s_waitcnt vmcnt(0)
    v_cmp_ne_u32 vcc, s67, v242
    s_cbranch_vccnz xa_poll_18
    buffer_load_dwordx4 v[196:199], v237, s[40:43], s55 offen sc1
    s_add_u32 s55, s55, 0x10000
    buffer_load_dwordx4 v[200:203], v237, s[40:43], s55 offen sc1
    s_add_u32 s55, s55, 0x10000
    buffer_load_dwordx4 v[204:207], v237, s[40:43], s55 offen sc1
    s_add_u32 s55, s55, 0x10000
    buffer_load_dwordx4 v[208:211], v237, s[40:43], s55 offen sc1
    s_sub_u32 s55, s55, 0x30000
    s_waitcnt vmcnt(0)
xa_ok_17:
    v_mfma_f32_16x16x32_bf16 v[4:7], v[196:199], v[212:215], v[4:7]
    v_mfma_f32_16x16x32_bf16 v[8:11], v[200:203], v[212:215], v[8:11]
    v_mfma_f32_16x16x32_bf16 v[12:15], v[204:207], v[212:215], v[12:15]
    v_mfma_f32_16x16x32_bf16 v[16:19], v[208:211], v[212:215], v[16:19]
    v_mfma_f32_16x16x32_bf16 v[20:23], v[196:199], v[216:219], v[20:23]
    v_mfma_f32_16x16x32_bf16 v[24:27], v[200:203], v[216:219], v[24:27]
    v_mfma_f32_16x16x32_bf16 v[28:31], v[204:207], v[216:219], v[28:31]
    v_mfma_f32_16x16x32_bf16 v[32:35], v[208:211], v[216:219], v[32:35]
    s_waitcnt lgkmcnt(7)
    v_pk_add_f32 v[100:101], v[100:101], v[4:5]
    v_pk_add_f32 v[102:103], v[102:103], v[6:7]
    s_waitcnt lgkmcnt(6)
    v_pk_add_f32 v[104:105], v[104:105], v[8:9]
    v_pk_add_f32 v[106:107], v[106:107], v[10:11]
    s_waitcnt lgkmcnt(5)
    v_pk_add_f32 v[108:109], v[108:109], v[12:13]
    v_pk_add_f32 v[110:111], v[110:111], v[14:15]
    s_waitcnt lgkmcnt(4)
    v_pk_add_f32 v[112:113], v[112:113], v[16:17]
    v_pk_add_f32 v[114:115], v[114:115], v[18:19]
    s_waitcnt lgkmcnt(3)
    v_pk_add_f32 v[116:117], v[116:117], v[20:21]
    v_pk_add_f32 v[118:119], v[118:119], v[22:23]
    s_waitcnt lgkmcnt(2)
    v_pk_add_f32 v[120:121], v[120:121], v[24:25]
    v_pk_add_f32 v[122:123], v[122:123], v[26:27]
    s_waitcnt lgkmcnt(1)
    v_pk_add_f32 v[124:125], v[124:125], v[28:29]
    v_pk_add_f32 v[126:127], v[126:127], v[30:31]
    s_waitcnt lgkmcnt(0)
    v_pk_add_f32 v[128:129], v[128:129], v[32:33]
    v_pk_add_f32 v[130:131], v[130:131], v[34:35]
    s_branch g2_kd_16
g2_k1_15:
    ds_write_b128 v240, v[4:7] offset:0
    ds_write_b128 v240, v[8:11] offset:1024
    ds_write_b128 v240, v[12:15] offset:2048
    ds_write_b128 v240, v[16:19] offset:3072
    ds_write_b128 v240, v[20:23] offset:4096
    ds_write_b128 v240, v[24:27] offset:5120
    ds_write_b128 v240, v[28:31] offset:6144
    ds_write_b128 v240, v[32:35] offset:7168
    s_waitcnt lgkmcnt(0)
    s_barrier
    ds_read_b128 v[100:103], v232 offset:0
    ds_read_b128 v[104:107], v232 offset:1024
    ds_read_b128 v[108:111], v232 offset:2048
    ds_read_b128 v[112:115], v232 offset:3072
    ds_read_b128 v[116:119], v232 offset:4096
    ds_read_b128 v[120:123], v232 offset:5120
    ds_read_b128 v[124:127], v232 offset:6144
    ds_read_b128 v[128:131], v232 offset:7168
    s_waitcnt vmcnt(0)
    v_cmp_ne_u32 vcc, s67, v242
    s_cbranch_vccz xa_ok_19
xa_poll_20:
    buffer_load_dword v242, v241, s[40:43], s56 offen sc1
    s_waitcnt vmcnt(0)
    v_cmp_ne_u32 vcc, s67, v242
    s_cbranch_vccnz xa_poll_20
    buffer_load_dwordx4 v[196:199], v237, s[40:43], s55 offen sc1
    s_add_u32 s55, s55, 0x10000
    buffer_load_dwordx4 v[200:203], v237, s[40:43], s55 offen sc1
    s_add_u32 s55, s55, 0x10000
    buffer_load_dwordx4 v[204:207], v237, s[40:43], s55 offen sc1
    s_add_u32 s55, s55, 0x10000
    buffer_load_dwordx4 v[208:211], v237, s[40:43], s55 offen sc1
    s_sub_u32 s55, s55, 0x30000
    s_waitcnt vmcnt(0)
xa_ok_19:
    v_mfma_f32_16x16x32_bf16 v[36:39], v[196:199], v[212:215], v[36:39]
    v_mfma_f32_16x16x32_bf16 v[40:43], v[200:203], v[212:215], v[40:43]
    v_mfma_f32_16x16x32_bf16 v[44:47], v[204:207], v[212:215], v[44:47]
    v_mfma_f32_16x16x32_bf16 v[48:51], v[208:211], v[212:215], v[48:51]
    v_mfma_f32_16x16x32_bf16 v[52:55], v[196:199], v[216:219], v[52:55]
    v_mfma_f32_16x16x32_bf16 v[56:59], v[200:203], v[216:219], v[56:59]
    v_mfma_f32_16x16x32_bf16 v[60:63], v[204:207], v[216:219], v[60:63]
    v_mfma_f32_16x16x32_bf16 v[64:67], v[208:211], v[216:219], v[64:67]
    s_waitcnt lgkmcnt(7)
    v_pk_add_f32 v[100:101], v[100:101], v[36:37]
    v_pk_add_f32 v[102:103], v[102:103], v[38:39]
    s_waitcnt lgkmcnt(6)
    v_pk_add_f32 v[104:105], v[104:105], v[40:41]
    v_pk_add_f32 v[106:107], v[106:107], v[42:43]
    s_waitcnt lgkmcnt(5)
    v_pk_add_f32 v[108:109], v[108:109], v[44:45]
    v_pk_add_f32 v[110:111], v[110:111], v[46:47]
    s_waitcnt lgkmcnt(4)
    v_pk_add_f32 v[112:113], v[112:113], v[48:49]
    v_pk_add_f32 v[114:115], v[114:115], v[50:51]
    s_waitcnt lgkmcnt(3)
    v_pk_add_f32 v[116:117], v[116:117], v[52:53]
    v_pk_add_f32 v[118:119], v[118:119], v[54:55]
    s_waitcnt lgkmcnt(2)
    v_pk_add_f32 v[120:121], v[120:121], v[56:57]
    v_pk_add_f32 v[122:123], v[122:123], v[58:59]
    s_waitcnt lgkmcnt(1)
    v_pk_add_f32 v[124:125], v[124:125], v[60:61]
    v_pk_add_f32 v[126:127], v[126:127], v[62:63]
    s_waitcnt lgkmcnt(0)
    v_pk_add_f32 v[128:129], v[128:129], v[64:65]
    v_pk_add_f32 v[130:131], v[130:131], v[66:67]
g2_kd_16:
    v_mul_u32_u24 v240, 1280, v238
    v_lshl_add_u32 v240, v239, 4, v240
    s_lshl_b32 s54, s60, 2
    s_add_u32 s54, s54, s68
    s_mul_i32 s54, s54, 40960
    s_lshl_b32 s55, s63, 7
    s_add_u32 s54, s54, s55
    v_cvt_pk_bf16_f32 v84, v100, v101
    v_cvt_pk_bf16_f32 v85, v102, v103
    v_cvt_pk_bf16_f32 v86, v104, v105
    v_cvt_pk_bf16_f32 v87, v106, v107
    v_cvt_pk_bf16_f32 v88, v108, v109
    v_cvt_pk_bf16_f32 v89, v110, v111
    v_cvt_pk_bf16_f32 v90, v112, v113
    v_cvt_pk_bf16_f32 v91, v114, v115
    v_cvt_pk_bf16_f32 v92, v116, v117
    v_cvt_pk_bf16_f32 v93, v118, v119
    v_cvt_pk_bf16_f32 v94, v120, v121
    v_cvt_pk_bf16_f32 v95, v122, v123
    v_cvt_pk_bf16_f32 v96, v124, v125
    v_cvt_pk_bf16_f32 v97, v126, v127
    v_cvt_pk_bf16_f32 v98, v128, v129
    v_cvt_pk_bf16_f32 v99, v130, v131
    s_nop 1
    v_permlane32_swap_b32 v84, v86
    v_permlane32_swap_b32 v85, v87
    v_permlane32_swap_b32 v88, v90
    v_permlane32_swap_b32 v89, v91
    v_permlane32_swap_b32 v92, v94
    v_permlane32_swap_b32 v93, v95
    v_permlane32_swap_b32 v96, v98
    v_permlane32_swap_b32 v97, v99
    s_nop 1
    v_permlane16_swap_b32 v84, v86
    v_permlane16_swap_b32 v85, v87
    v_permlane16_swap_b32 v88, v90
    v_permlane16_swap_b32 v89, v91
    v_permlane16_swap_b32 v92, v94
    v_permlane16_swap_b32 v93, v95
    v_permlane16_swap_b32 v96, v98
    v_permlane16_swap_b32 v97, v99
    s_nop 1
    buffer_store_dwordx4 v[84:87], v240, s[44:47], s54 offen offset:0
    buffer_store_dwordx4 v[88:91], v240, s[44:47], s54 offen offset:64
    s_add_u32 s54, s54, 20480
    buffer_store_dwordx4 v[92:95], v240, s[44:47], s54 offen offset:0
    buffer_store_dwordx4 v[96:99], v240, s[44:47], s54 offen offset:64
    s_endpgm
g_help:
    s_sub_u32 s52, s30, 4
    s_lshl_b32 s53, s60, 7
    s_lshl_b32 s56, s52, 5
    s_add_u32 s53, s53, s56
    v_lshrrev_b32 v10, 3, v0
    v_and_b32 v11, 7, v0
    v_add_u32 v12, 0, v10
    v_bfe_u32 v1, v12, 1, 3
    v_xor_b32 v1, v1, v11
    v_lshlrev_b32 v1, 4, v1
    v_add_u32 v12, s53, v12
    v_mul_u32_u24 v12, 1280, v12
    v_add_u32 v1, v1, v12
    v_add_u32 v12, 8, v10
    v_bfe_u32 v2, v12, 1, 3
    v_xor_b32 v2, v2, v11
    v_lshlrev_b32 v2, 4, v2
    v_add_u32 v12, s53, v12
    v_mul_u32_u24 v12, 1280, v12
    v_add_u32 v2, v2, v12
    v_subrev_u32 v2, 1024, v2
    v_add_u32 v12, 16, v10
    v_bfe_u32 v3, v12, 1, 3
    v_xor_b32 v3, v3, v11
    v_lshlrev_b32 v3, 4, v3
    v_add_u32 v12, s53, v12
    v_mul_u32_u24 v12, 1280, v12
    v_add_u32 v3, v3, v12
    v_subrev_u32 v3, 2048, v3
    v_add_u32 v12, 24, v10
    v_bfe_u32 v4, v12, 1, 3
    v_xor_b32 v4, v4, v11
    v_lshlrev_b32 v4, 4, v4
    v_add_u32 v12, s53, v12
    v_mul_u32_u24 v12, 1280, v12
    v_add_u32 v4, v4, v12
    v_subrev_u32 v4, 3072, v4
    s_mul_i32 s53, s52, 320
    s_mul_i32 s56, s61, 320
    v_add_u32 v10, s53, v0
    v_mul_u32_u24 v11, 3277, v10
    v_lshrrev_b32 v11, 16, v11
    v_mul_u32_u24 v12, 20, v11
    v_sub_u32 v10, v10, v12
    v_bfe_u32 v12, v11, 3, 1
    v_lshlrev_b32 v12, 1, v12
    v_xor_b32 v10, v10, v12
    v_lshlrev_b32 v10, 4, v10
    v_mul_u32_u24 v11, 3456, v11
    v_add3_u32 v5, v10, v11, s56
    v_add_u32 v10, s53, v0
    v_add_u32 v10, 64, v10
    v_mul_u32_u24 v11, 3277, v10
    v_lshrrev_b32 v11, 16, v11
    v_mul_u32_u24 v12, 20, v11
    v_sub_u32 v10, v10, v12
    v_bfe_u32 v12, v11, 3, 1
    v_lshlrev_b32 v12, 1, v12
    v_xor_b32 v10, v10, v12
    v_lshlrev_b32 v10, 4, v10
    v_mul_u32_u24 v11, 3456, v11
    v_add3_u32 v6, v10, v11, s56
    v_subrev_u32 v6, 1024, v6
    v_add_u32 v10, s53, v0
    v_add_u32 v10, 128, v10
    v_mul_u32_u24 v11, 3277, v10
    v_lshrrev_b32 v11, 16, v11
    v_mul_u32_u24 v12, 20, v11
    v_sub_u32 v10, v10, v12
    v_bfe_u32 v12, v11, 3, 1
    v_lshlrev_b32 v12, 1, v12
    v_xor_b32 v10, v10, v12
    v_lshlrev_b32 v10, 4, v10
    v_mul_u32_u24 v11, 3456, v11
    v_add3_u32 v7, v10, v11, s56
    v_subrev_u32 v7, 2048, v7
    v_add_u32 v10, s53, v0
    v_add_u32 v10, 192, v10
    v_mul_u32_u24 v11, 3277, v10
    v_lshrrev_b32 v11, 16, v11
    v_mul_u32_u24 v12, 20, v11
    v_sub_u32 v10, v10, v12
    v_bfe_u32 v12, v11, 3, 1
    v_lshlrev_b32 v12, 1, v12
    v_xor_b32 v10, v10, v12
    v_lshlrev_b32 v10, 4, v10
    v_mul_u32_u24 v11, 3456, v11
    v_add3_u32 v8, v10, v11, s56
    v_subrev_u32 v8, 3072, v8
    v_add_u32 v10, s53, v0
    v_add_u32 v10, 256, v10
    v_mul_u32_u24 v11, 3277, v10
    v_lshrrev_b32 v11, 16, v11
    v_mul_u32_u24 v12, 20, v11
    v_sub_u32 v10, v10, v12
    v_bfe_u32 v12, v11, 3, 1
    v_lshlrev_b32 v12, 1, v12
    v_xor_b32 v10, v10, v12
    v_lshlrev_b32 v10, 4, v10
    v_mul_u32_u24 v11, 3456, v11
    v_add3_u32 v9, v10, v11, s56
    s_lshl_b32 s53, s52, 12
    s_mul_i32 s56, s52, 5120
    s_add_u32 s56, s56, 16384
    s_lshl_b32 s54, s62, 7
    s_mul_i32 s55, s62, 221184
    s_add_u32 m0, s53, 0
    s_nop 0
    buffer_load_dwordx4 v1, s[32:35], s54 offen offset:0 lds
    buffer_load_dwordx4 v2, s[32:35], s54 offen offset:1024 lds
    buffer_load_dwordx4 v3, s[32:35], s54 offen offset:2048 lds
    buffer_load_dwordx4 v4, s[32:35], s54 offen offset:3072 lds
    s_add_u32 m0, s56, 0
    s_nop 0
    buffer_load_dwordx4 v5, s[36:39], s55 offen offset:0 lds
    buffer_load_dwordx4 v6, s[36:39], s55 offen offset:1024 lds
    buffer_load_dwordx4 v7, s[36:39], s55 offen offset:2048 lds
    buffer_load_dwordx4 v8, s[36:39], s55 offen offset:3072 lds
    s_add_u32 m0, s56, 4096
    s_nop 0
    buffer_load_dwordx4 v9, s[36:39], s55 offen lds
    s_add_u32 s62, s62, 1
    s_cmp_eq_u32 s62, 10
    s_cselect_b32 s62, 0, s62
    s_lshl_b32 s54, s62, 7
    s_mul_i32 s55, s62, 221184
    s_add_u32 m0, s53, 36864
    s_nop 0
    buffer_load_dwordx4 v1, s[32:35], s54 offen offset:0 lds
    buffer_load_dwordx4 v2, s[32:35], s54 offen offset:1024 lds
    buffer_load_dwordx4 v3, s[32:35], s54 offen offset:2048 lds
    buffer_load_dwordx4 v4, s[32:35], s54 offen offset:3072 lds
    s_add_u32 m0, s56, 36864
    s_nop 0
    buffer_load_dwordx4 v5, s[36:39], s55 offen offset:0 lds
    buffer_load_dwordx4 v6, s[36:39], s55 offen offset:1024 lds
    buffer_load_dwordx4 v7, s[36:39], s55 offen offset:2048 lds
    buffer_load_dwordx4 v8, s[36:39], s55 offen offset:3072 lds
    s_add_u32 m0, s56, 40960
    s_nop 0
    buffer_load_dwordx4 v9, s[36:39], s55 offen lds
    s_sub_u32 s68, s30, 4
    v_lshrrev_b32 v14, 3, v0
    v_bfe_u32 v15, v0, 4, 2
    v_lshlrev_b32 v15, 1, v15
    v_and_b32 v13, 7, v0
    v_xor_b32 v13, v13, v15
    v_lshlrev_b32 v13, 4, v13
    v_mul_u32_u24 v14, 1280, v14
    v_add_u32 v13, v13, v14
    s_mul_i32 s69, s68, 61440
    s_lshl_b32 s71, s63, 7
    s_add_u32 s69, s69, s71
    s_mul_i32 s70, s68, 6144
    s_mul_i32 s59, s65, 245760
    v_lshlrev_b32 v88, 4, v0
    v_add_u32 v88, s70, v88
    s_waitcnt vmcnt(9)
    s_barrier
    s_add_u32 s62, s62, 1
    s_cmp_eq_u32 s62, 10
    s_cselect_b32 s62, 0, s62
    s_lshl_b32 s54, s62, 7
    s_mul_i32 s55, s62, 221184
    s_add_u32 m0, s53, 73728
    s_nop 0
    buffer_load_dwordx4 v1, s[32:35], s54 offen offset:0 lds
    buffer_load_dwordx4 v2, s[32:35], s54 offen offset:1024 lds
    buffer_load_dwordx4 v3, s[32:35], s54 offen offset:2048 lds
    buffer_load_dwordx4 v4, s[32:35], s54 offen offset:3072 lds
    s_add_u32 m0, s56, 73728
    s_nop 0
    buffer_load_dwordx4 v5, s[36:39], s55 offen offset:0 lds
    buffer_load_dwordx4 v6, s[36:39], s55 offen offset:1024 lds
    buffer_load_dwordx4 v7, s[36:39], s55 offen offset:2048 lds
    buffer_load_dwordx4 v8, s[36:39], s55 offen offset:3072 lds
    s_add_u32 m0, s56, 77824
    s_nop 0
    buffer_load_dwordx4 v9, s[36:39], s55 offen lds
    s_waitcnt vmcnt(9)
    s_barrier
    s_add_u32 s62, s62, 1
    s_cmp_eq_u32 s62, 10
    s_cselect_b32 s62, 0, s62
    s_lshl_b32 s54, s62, 7
    s_mul_i32 s55, s62, 221184
    s_add_u32 m0, s53, 110592
    s_nop 0
    buffer_load_dwordx4 v1, s[32:35], s54 offen offset:0 lds
    buffer_load_dwordx4 v2, s[32:35], s54 offen offset:1024 lds
    buffer_load_dwordx4 v3, s[32:35], s54 offen offset:2048 lds
    buffer_load_dwordx4 v4, s[32:35], s54 offen offset:3072 lds
    s_add_u32 m0, s56, 110592
    s_nop 0
    buffer_load_dwordx4 v5, s[36:39], s55 offen offset:0 lds
    buffer_load_dwordx4 v6, s[36:39], s55 offen offset:1024 lds
    buffer_load_dwordx4 v7, s[36:39], s55 offen offset:2048 lds
    buffer_load_dwordx4 v8, s[36:39], s55 offen offset:3072 lds
    s_add_u32 m0, s56, 114688
    s_nop 0
    buffer_load_dwordx4 v9, s[36:39], s55 offen lds
    s_waitcnt vmcnt(9)
    s_barrier
    s_add_u32 s62, s62, 1
    s_cmp_eq_u32 s62, 10
    s_cselect_b32 s62, 0, s62
    s_lshl_b32 s54, s62, 7
    s_mul_i32 s55, s62, 221184
    s_add_u32 m0, s53, 0
    s_nop 0
    buffer_load_dwordx4 v1, s[32:35], s54 offen offset:0 lds
    buffer_load_dwordx4 v2, s[32:35], s54 offen offset:1024 lds
    buffer_load_dwordx4 v3, s[32:35], s54 offen offset:2048 lds
    buffer_load_dwordx4 v4, s[32:35], s54 offen offset:3072 lds
    s_add_u32 m0, s56, 0
    s_nop 0
    buffer_load_dwordx4 v5, s[36:39], s55 offen offset:0 lds
    buffer_load_dwordx4 v6, s[36:39], s55 offen offset:1024 lds
    buffer_load_dwordx4 v7, s[36:39], s55 offen offset:2048 lds
    buffer_load_dwordx4 v8, s[36:39], s55 offen offset:3072 lds
    s_add_u32 m0, s56, 4096
    s_nop 0
    buffer_load_dwordx4 v9, s[36:39], s55 offen lds
    s_waitcnt vmcnt(9)
    s_barrier
    s_add_u32 s62, s62, 1
    s_cmp_eq_u32 s62, 10
    s_cselect_b32 s62, 0, s62
    s_lshl_b32 s54, s62, 7
    s_mul_i32 s55, s62, 221184
    s_add_u32 m0, s53, 36864
    s_nop 0
    buffer_load_dwordx4 v1, s[32:35], s54 offen offset:0 lds
    buffer_load_dwordx4 v2, s[32:35], s54 offen offset:1024 lds
    buffer_load_dwordx4 v3, s[32:35], s54 offen offset:2048 lds
    buffer_load_dwordx4 v4, s[32:35], s54 offen offset:3072 lds
    s_add_u32 m0, s56, 36864
    s_nop 0
    buffer_load_dwordx4 v5, s[36:39], s55 offen offset:0 lds
    buffer_load_dwordx4 v6, s[36:39], s55 offen offset:1024 lds
    buffer_load_dwordx4 v7, s[36:39], s55 offen offset:2048 lds
    buffer_load_dwordx4 v8, s[36:39], s55 offen offset:3072 lds
    s_add_u32 m0, s56, 40960
    s_nop 0
    buffer_load_dwordx4 v9, s[36:39], s55 offen lds
    s_waitcnt vmcnt(9)
    s_barrier
    s_add_u32 s62, s62, 1
    s_cmp_eq_u32 s62, 10
    s_cselect_b32 s62, 0, s62
    s_lshl_b32 s54, s62, 7
    s_mul_i32 s55, s62, 221184
    s_add_u32 m0, s53, 73728
    s_nop 0
    buffer_load_dwordx4 v1, s[32:35], s54 offen offset:0 lds
    buffer_load_dwordx4 v2, s[32:35], s54 offen offset:1024 lds
    buffer_load_dwordx4 v3, s[32:35], s54 offen offset:2048 lds
    buffer_load_dwordx4 v4, s[32:35], s54 offen offset:3072 lds
    s_add_u32 m0, s56, 73728
    s_nop 0
    buffer_load_dwordx4 v5, s[36:39], s55 offen offset:0 lds
    buffer_load_dwordx4 v6, s[36:39], s55 offen offset:1024 lds
    buffer_load_dwordx4 v7, s[36:39], s55 offen offset:2048 lds
    buffer_load_dwordx4 v8, s[36:39], s55 offen offset:3072 lds
    s_add_u32 m0, s56, 77824
    s_nop 0
    buffer_load_dwordx4 v9, s[36:39], s55 offen lds
    s_add_u32 s62, s62, 1
    s_cmp_eq_u32 s62, 10
    s_cselect_b32 s62, 0, s62
    s_lshl_b32 s54, s62, 7
    s_mul_i32 s55, s62, 221184
    s_add_u32 m0, s53, 110592
    s_nop 0
    buffer_load_dwordx4 v1, s[32:35], s54 offen offset:0 lds
    buffer_load_dwordx4 v2, s[32:35], s54 offen offset:1024 lds
    buffer_load_dwordx4 v3, s[32:35], s54 offen offset:2048 lds
    buffer_load_dwordx4 v4, s[32:35], s54 offen offset:3072 lds
    s_add_u32 m0, s56, 110592
    s_nop 0
    buffer_load_dwordx4 v5, s[36:39], s55 offen offset:0 lds
    buffer_load_dwordx4 v6, s[36:39], s55 offen offset:1024 lds
    buffer_load_dwordx4 v7, s[36:39], s55 offen offset:2048 lds
    buffer_load_dwordx4 v8, s[36:39], s55 offen offset:3072 lds
    s_add_u32 m0, s56, 114688
    s_nop 0
    buffer_load_dwordx4 v9, s[36:39], s55 offen lds
    s_waitcnt vmcnt(18)
    s_barrier
    s_add_u32 s62, s62, 1
    s_cmp_eq_u32 s62, 10
    s_cselect_b32 s62, 0, s62
    s_lshl_b32 s54, s62, 7
    s_mul_i32 s55, s62, 221184
    s_add_u32 m0, s53, 0
    s_nop 0
    buffer_load_dwordx4 v1, s[32:35], s54 offen offset:0 lds
    buffer_load_dwordx4 v2, s[32:35], s54 offen offset:1024 lds
    buffer_load_dwordx4 v3, s[32:35], s54 offen offset:2048 lds
    buffer_load_dwordx4 v4, s[32:35], s54 offen offset:3072 lds
    s_add_u32 m0, s56, 0
    s_nop 0
    buffer_load_dwordx4 v5, s[36:39], s55 offen offset:0 lds
    buffer_load_dwordx4 v6, s[36:39], s55 offen offset:1024 lds
    buffer_load_dwordx4 v7, s[36:39], s55 offen offset:2048 lds
    buffer_load_dwordx4 v8, s[36:39], s55 offen offset:3072 lds
    s_add_u32 m0, s56, 4096
    s_nop 0
    buffer_load_dwordx4 v9, s[36:39], s55 offen lds
    s_waitcnt vmcnt(18)
    s_barrier
    s_add_u32 s62, s62, 1
    s_cmp_eq_u32 s62, 10
    s_cselect_b32 s62, 0, s62
    s_lshl_b32 s54, s62, 7
    s_mul_i32 s55, s62, 221184
    s_add_u32 m0, s53, 36864
    s_nop 0
    buffer_load_dwordx4 v1, s[32:35], s54 offen offset:0 lds
    buffer_load_dwordx4 v2, s[32:35], s54 offen offset:1024 lds
    buffer_load_dwordx4 v3, s[32:35], s54 offen offset:2048 lds
    buffer_load_dwordx4 v4, s[32:35], s54 offen offset:3072 lds
    s_add_u32 m0, s56, 36864
    s_nop 0
    buffer_load_dwordx4 v5, s[36:39], s55 offen offset:0 lds
    buffer_load_dwordx4 v6, s[36:39], s55 offen offset:1024 lds
    buffer_load_dwordx4 v7, s[36:39], s55 offen offset:2048 lds
    buffer_load_dwordx4 v8, s[36:39], s55 offen offset:3072 lds
    s_add_u32 m0, s56, 40960
    s_nop 0
    buffer_load_dwordx4 v9, s[36:39], s55 offen lds
    s_waitcnt vmcnt(18)
    s_barrier
    s_add_u32 s71, s59, 1474560
    s_cmp_ge_u32 s71, 2211840
    s_cselect_b32 s68, 2211840, 0
    s_sub_u32 s71, s71, s68
    s_add_u32 s71, s71, s69
    buffer_load_dwordx4 v[16:19], v13, s[72:75], s71 offen
    s_add_u32 s71, s71, 10240
    buffer_load_dwordx4 v[20:23], v13, s[72:75], s71 offen
    s_add_u32 s71, s71, 10240
    buffer_load_dwordx4 v[24:27], v13, s[72:75], s71 offen
    s_add_u32 s71, s71, 10240
    buffer_load_dwordx4 v[28:31], v13, s[72:75], s71 offen
    s_add_u32 s71, s71, 10240
    buffer_load_dwordx4 v[32:35], v13, s[72:75], s71 offen
    s_add_u32 s71, s71, 10240
    buffer_load_dwordx4 v[36:39], v13, s[72:75], s71 offen
    s_waitcnt vmcnt(15)
    s_barrier
    v_lshlrev_b32 v10, 4, v0
    s_lshl_b32 s54, s60, 10
    s_add_u32 s54, s54, 0x700000
    s_mul_i32 s55, s61, 1280
    s_add_u32 s55, s55, 0x707c00
    s_lshl_b32 s57, s52, 10
    s_add_u32 s55, s55, s57
    s_cmp_eq_u32 s52, 0
    s_cselect_b32 s55, s54, s55
    s_add_u32 m0, s57, 147456
    s_nop 0
    buffer_load_dwordx4 v10, s[40:43], s55 offen sc1 lds
    s_add_u32 s71, s59, 0
    s_cmp_ge_u32 s71, 2211840
    s_cselect_b32 s68, 2211840, 0
    s_sub_u32 s71, s71, s68
    s_add_u32 s71, s71, s69
    s_add_u32 m0, s70, 73728
    s_nop 0
    buffer_load_dwordx4 v13, s[72:75], s71 offen lds
    s_add_u32 s71, s71, 10240
    s_add_u32 m0, s70, 74752
    s_nop 0
    buffer_load_dwordx4 v13, s[72:75], s71 offen lds
    s_add_u32 s71, s71, 10240
    s_add_u32 m0, s70, 75776
    s_nop 0
    buffer_load_dwordx4 v13, s[72:75], s71 offen lds
    s_add_u32 s71, s71, 10240
    s_add_u32 m0, s70, 76800
    s_nop 0
    buffer_load_dwordx4 v13, s[72:75], s71 offen lds
    s_add_u32 s71, s71, 10240
    s_add_u32 m0, s70, 77824
    s_nop 0
    buffer_load_dwordx4 v13, s[72:75], s71 offen lds
    s_add_u32 s71, s71, 10240
    s_add_u32 m0, s70, 78848
    s_nop 0
    buffer_load_dwordx4 v13, s[72:75], s71 offen lds
    s_waitcnt vmcnt(13)
    s_barrier
    s_add_u32 s71, s59, 245760
    s_cmp_ge_u32 s71, 2211840
    s_cselect_b32 s68, 2211840, 0
    s_sub_u32 s71, s71, s68
    s_add_u32 s71, s71, s69
    s_add_u32 m0, s70, 98304
    s_nop 0
    buffer_load_dwordx4 v13, s[72:75], s71 offen lds
    s_add_u32 s71, s71, 10240
    s_add_u32 m0, s70, 99328
    s_nop 0
    buffer_load_dwordx4 v13, s[72:75], s71 offen lds
    s_add_u32 s71, s71, 10240
    s_add_u32 m0, s70, 100352
    s_nop 0
    buffer_load_dwordx4 v13, s[72:75], s71 offen lds
    s_add_u32 s71, s71, 10240
    s_add_u32 m0, s70, 101376
    s_nop 0
    buffer_load_dwordx4 v13, s[72:75], s71 offen lds
    s_add_u32 s71, s71, 10240
    s_add_u32 m0, s70, 102400
    s_nop 0
    buffer_load_dwordx4 v13, s[72:75], s71 offen lds
    s_add_u32 s71, s71, 10240
    s_add_u32 m0, s70, 103424
    s_nop 0
    buffer_load_dwordx4 v13, s[72:75], s71 offen lds
    s_waitcnt vmcnt(12)
    s_barrier
    s_barrier
    s_barrier
    s_cmp_ge_u32 s64, 20
    s_cbranch_scc1 g_help_end
    s_add_u32 s71, s59, 491520
    s_cmp_ge_u32 s71, 2211840
    s_cselect_b32 s68, 2211840, 0
    s_sub_u32 s71, s71, s68
    s_add_u32 s71, s71, s69
    s_add_u32 m0, s70, 122880
    s_nop 0
    buffer_load_dwordx4 v13, s[72:75], s71 offen lds
    s_add_u32 s71, s71, 10240
    s_add_u32 m0, s70, 123904
    s_nop 0
    buffer_load_dwordx4 v13, s[72:75], s71 offen lds
    s_add_u32 s71, s71, 10240
    s_add_u32 m0, s70, 124928
    s_nop 0
    buffer_load_dwordx4 v13, s[72:75], s71 offen lds
    s_add_u32 s71, s71, 10240
    s_add_u32 m0, s70, 125952
    s_nop 0
    buffer_load_dwordx4 v13, s[72:75], s71 offen lds
    s_add_u32 s71, s71, 10240
    s_add_u32 m0, s70, 126976
    s_nop 0
    buffer_load_dwordx4 v13, s[72:75], s71 offen lds
    s_add_u32 s71, s71, 10240
    s_add_u32 m0, s70, 128000
    s_nop 0
    buffer_load_dwordx4 v13, s[72:75], s71 offen lds
    s_add_u32 s71, s59, 737280
    s_cmp_ge_u32 s71, 2211840
    s_cselect_b32 s68, 2211840, 0
    s_sub_u32 s71, s71, s68
    s_add_u32 s71, s71, s69
    s_add_u32 m0, s70, 0
    s_nop 0
    buffer_load_dwordx4 v13, s[72:75], s71 offen lds
    s_add_u32 s71, s71, 10240
    s_add_u32 m0, s70, 1024
    s_nop 0
    buffer_load_dwordx4 v13, s[72:75], s71 offen lds
    s_add_u32 s71, s71, 10240
    s_add_u32 m0, s70, 2048
    s_nop 0
    buffer_load_dwordx4 v13, s[72:75], s71 offen lds
    s_add_u32 s71, s71, 10240
    s_add_u32 m0, s70, 3072
    s_nop 0
    buffer_load_dwordx4 v13, s[72:75], s71 offen lds
    s_add_u32 s71, s71, 10240
    s_add_u32 m0, s70, 4096
    s_nop 0
    buffer_load_dwordx4 v13, s[72:75], s71 offen lds
    s_add_u32 s71, s71, 10240
    s_add_u32 m0, s70, 5120
    s_nop 0
    buffer_load_dwordx4 v13, s[72:75], s71 offen lds
    s_add_u32 s71, s59, 983040
    s_cmp_ge_u32 s71, 2211840
    s_cselect_b32 s68, 2211840, 0
    s_sub_u32 s71, s71, s68
    s_add_u32 s71, s71, s69
    s_add_u32 m0, s70, 24576
    s_nop 0
    buffer_load_dwordx4 v13, s[72:75], s71 offen lds
    s_add_u32 s71, s71, 10240
    s_add_u32 m0, s70, 25600
    s_nop 0
    buffer_load_dwordx4 v13, s[72:75], s71 offen lds
    s_add_u32 s71, s71, 10240
    s_add_u32 m0, s70, 26624
    s_nop 0
    buffer_load_dwordx4 v13, s[72:75], s71 offen lds
    s_add_u32 s71, s71, 10240
    s_add_u32 m0, s70, 27648
    s_nop 0
    buffer_load_dwordx4 v13, s[72:75], s71 offen lds
    s_add_u32 s71, s71, 10240
    s_add_u32 m0, s70, 28672
    s_nop 0
    buffer_load_dwordx4 v13, s[72:75], s71 offen lds
    s_add_u32 s71, s71, 10240
    s_add_u32 m0, s70, 29696
    s_nop 0
    buffer_load_dwordx4 v13, s[72:75], s71 offen lds
    s_add_u32 s71, s59, 1228800
    s_cmp_ge_u32 s71, 2211840
    s_cselect_b32 s68, 2211840, 0
    s_sub_u32 s71, s71, s68
    s_add_u32 s71, s71, s69
    s_add_u32 m0, s70, 49152
    s_nop 0
    buffer_load_dwordx4 v13, s[72:75], s71 offen lds
    s_add_u32 s71, s71, 10240
    s_add_u32 m0, s70, 50176
    s_nop 0
    buffer_load_dwordx4 v13, s[72:75], s71 offen lds
    s_add_u32 s71, s71, 10240
    s_add_u32 m0, s70, 51200
    s_nop 0
    buffer_load_dwordx4 v13, s[72:75], s71 offen lds
    s_add_u32 s71, s71, 10240
    s_add_u32 m0, s70, 52224
    s_nop 0
    buffer_load_dwordx4 v13, s[72:75], s71 offen lds
    s_add_u32 s71, s71, 10240
    s_add_u32 m0, s70, 53248
    s_nop 0
    buffer_load_dwordx4 v13, s[72:75], s71 offen lds
    s_add_u32 s71, s71, 10240
    s_add_u32 m0, s70, 54272
    s_nop 0
    buffer_load_dwordx4 v13, s[72:75], s71 offen lds
    s_add_u32 s71, s59, 1720320
    s_cmp_ge_u32 s71, 2211840
    s_cselect_b32 s68, 2211840, 0
    s_sub_u32 s71, s71, s68
    s_add_u32 s71, s71, s69
    buffer_load_dwordx4 v[40:43], v13, s[72:75], s71 offen
    s_add_u32 s71, s71, 10240
    buffer_load_dwordx4 v[44:47], v13, s[72:75], s71 offen
    s_add_u32 s71, s71, 10240
    buffer_load_dwordx4 v[48:51], v13, s[72:75], s71 offen
    s_add_u32 s71, s71, 10240
    buffer_load_dwordx4 v[52:55], v13, s[72:75], s71 offen
    s_add_u32 s71, s71, 10240
    buffer_load_dwordx4 v[56:59], v13, s[72:75], s71 offen
    s_add_u32 s71, s71, 10240
    buffer_load_dwordx4 v[60:63], v13, s[72:75], s71 offen
    v_min_u32 v89, 10, v0
    v_lshlrev_b32 v89, 7, v89
    s_lshl_b32 s54, s66, 11
    s_add_u32 s54, s54, 0xe00000
    s_lshl_b32 s55, s30, 8
    s_add_u32 m0, s55, 158976
    s_nop 0
    buffer_load_dword v89, s[40:43], s54 offen sc1 lds
    s_add_u32 s71, s59, 1966080
    s_cmp_ge_u32 s71, 2211840
    s_cselect_b32 s68, 2211840, 0
    s_sub_u32 s71, s71, s68
    s_add_u32 s71, s71, s69
    buffer_load_dwordx4 v[64:67], v13, s[72:75], s71 offen
    s_add_u32 s71, s71, 10240
    buffer_load_dwordx4 v[68:71], v13, s[72:75], s71 offen
    s_add_u32 s71, s71, 10240
    buffer_load_dwordx4 v[72:75], v13, s[72:75], s71 offen
    s_add_u32 s71, s71, 10240
    buffer_load_dwordx4 v[76:79], v13, s[72:75], s71 offen
    s_add_u32 s71, s71, 10240
    buffer_load_dwordx4 v[80:83], v13, s[72:75], s71 offen
    s_add_u32 s71, s71, 10240
    buffer_load_dwordx4 v[84:87], v13, s[72:75], s71 offen
    s_waitcnt vmcnt(6)
    s_barrier
    s_waitcnt vmcnt(37)
    s_barrier
    s_waitcnt vmcnt(31)
    s_barrier
    s_waitcnt vmcnt(49)
    v_add_u32 v14, 73728, v88
    ds_write_b128 v14, v[16:19] offset:0
    ds_write_b128 v14, v[20:23] offset:1024
    ds_write_b128 v14, v[24:27] offset:2048
    ds_write_b128 v14, v[28:31] offset:3072
    ds_write_b128 v14, v[32:35] offset:4096
    ds_write_b128 v14, v[36:39] offset:5120
    s_waitcnt vmcnt(25)
    s_barrier
    s_waitcnt vmcnt(7)
    v_add_u32 v14, 98304, v88
    ds_write_b128 v14, v[40:43] offset:0
    ds_write_b128 v14, v[44:47] offset:1024
    ds_write_b128 v14, v[48:51] offset:2048
    ds_write_b128 v14, v[52:55] offset:3072
    ds_write_b128 v14, v[56:59] offset:4096
    ds_write_b128 v14, v[60:63] offset:5120
    s_waitcnt vmcnt(19)
    s_barrier
    s_waitcnt vmcnt(0)
    v_add_u32 v14, 122880, v88
    ds_write_b128 v14, v[64:67] offset:0
    ds_write_b128 v14, v[68:71] offset:1024
    ds_write_b128 v14, v[72:75] offset:2048
    ds_write_b128 v14, v[76:79] offset:3072
    ds_write_b128 v14, v[80:83] offset:4096
    ds_write_b128 v14, v[84:87] offset:5120
    s_waitcnt vmcnt(13)
    s_barrier
    s_waitcnt lgkmcnt(0)
    s_barrier
    s_waitcnt lgkmcnt(0)
    s_barrier
    s_waitcnt lgkmcnt(0)
    s_barrier
    s_barrier
g_help_end:
    s_waitcnt vmcnt(0)
k_wait:
    s_waitcnt vmcnt(0)
k_end:
    s_endpgm
.section .rodata,"a"
.p2align 6
.amdhsa_kernel parallel_sum__ssm_conv_s4d__dense_activation_relu__prompt_kernel
  .amdhsa_next_free_vgpr 244
  .amdhsa_next_free_sgpr 102
  .amdhsa_accum_offset 244
  .amdhsa_group_segment_fixed_size 0
  .amdhsa_kernarg_size 104
  .amdhsa_user_sgpr_count 2
  .amdhsa_user_sgpr_kernarg_segment_ptr 1
  .amdhsa_system_sgpr_workgroup_id_x 1
  .amdhsa_float_denorm_mode_32 3
.end_amdhsa_kernel
```
